```python
import torch

def _softmax(x, axis=-1):
    return torch.softmax(x, dim=axis)
def _gelu(x):
    return torch.nn.functional.gelu(x, approximate="tanh")
def _silu(x):
    return torch.nn.functional.silu(x)
def _sigmoid(x):
    return torch.sigmoid(x)
def _layernorm(x, axis=-1, eps=1e-5):
    m = x.mean(dim=axis, keepdim=True)
    v = x.var(dim=axis, keepdim=True, unbiased=False)
    return (x - m) / torch.sqrt(v + eps)
def _scatter_add(tgt, idx, src, axis=0):
    return tgt.clone().index_add_(axis, idx, src)
def _segment_sum(src, seg, n):
    out = torch.zeros((n,) + src.shape[1:], dtype=src.dtype)
    return out.index_add_(0, seg, src)
def _pad(x, pw):
    flat = tuple(v for pair in reversed(pw) for v in pair)
    return torch.nn.functional.pad(x, flat)

kernel_name = 'standalone__gqa_block_cached__near_ridge'

def setup_inputs():

    _w = (lambda a: (lambda t: t.to(torch.bfloat16) if t.is_floating_point() else t)(torch.as_tensor(a)))
    B, Sq, D = 16, 64, 448
    Hq, Hkv, Sk, Dh = 16, 8, 512, 256
    assert Hq % Hkv == 0, (Hq, Hkv)
    return {
        "x": _w((lambda *s: torch.randn(*s, dtype=torch.bfloat16) * 0.8)(B, Sq, D)),
        "k_cache": _w((lambda *s: torch.randn(*s, dtype=torch.bfloat16) * 0.8)(B, Hkv, Sk, Dh)),
        "v_cache": _w((lambda *s: torch.randn(*s, dtype=torch.bfloat16) * 0.05)(B, Hkv, Sk, Dh)),
        "wq": _w((lambda *s: torch.randn(*s, dtype=torch.bfloat16) * 0.8)(D, Hq * Dh) * (D ** -0.5)),
        "wo": _w((lambda *s: torch.randn(*s, dtype=torch.bfloat16) * 0.05)(Hq * Dh, D) * ((Hq * Dh) ** -0.5)),
    }

def reference(x, k_cache, v_cache, wq, wo):
    B, Sq, D = x.shape
    Hq, Dh = 16, 256
    Hkv = k_cache.shape[1]
    rep = Hq // Hkv
    q = (lambda x, *d: x.permute(*d))((x @ wq).reshape(B, Sq, Hq, Dh), 0, 2, 1, 3)
    k = (lambda x, n, axis: torch.repeat_interleave(x, n, dim=axis))(k_cache, rep, axis=1)
    v = (lambda x, n, axis: torch.repeat_interleave(x, n, dim=axis))(v_cache, rep, axis=1)
    scores = torch.einsum("bhqd,bhkd->bhqk", q, k) * (Dh ** -0.5)
    p = _softmax(scores, axis=-1)
    o = torch.einsum("bhqk,bhkd->bhqd", p, v)
    return (lambda x, *d: x.permute(*d))(o, 0, 2, 1, 3).reshape(B, Sq, Hq * Dh) @ wo
```

```asm
; @launch grid=(256,1,1) block=(256,1,1) lds=163840
.amdgcn_target "amdgcn-amd-amdhsa--gfx950"
.text
.globl standalone__gqa_block_cached__near_ridge_kernel
.p2align 8
.type standalone__gqa_block_cached__near_ridge_kernel,@function
standalone__gqa_block_cached__near_ridge_kernel:
    s_cmp_ge_u32 s2, 256
    s_cbranch_scc1 L_end_main
    s_load_dwordx16 s[4:19], s[0:1], 0
    v_lshrrev_b32 v1, 6, v0
    v_and_b32 v0, 63, v0
    v_readfirstlane_b32 s44, v1
    v_mov_b32 v37, 1073741824
    s_getpc_b64 s[36:37]
L_pc:
    s_and_b32 s37, s37, 65535
    s_mov_b32 s38, L_code_end-L_pc
    s_mov_b32 s39, 131072
    v_lshlrev_b32 v119, 7, v0
    v_cmp_gt_u32 vcc, 3, v0
    s_nop 1
    v_cndmask_b32 v119, v37, v119, vcc
    s_lshr_b32 s54, s2, 3
    s_lshl_b32 s54, s54, 2
    s_add_u32 s54, s54, s44
    s_mul_i32 s54, s54, 384
    buffer_load_dword v120, v119, s[36:39], s54 offen
    s_lshr_b32 s45, s2, 4
    s_bfe_u32 s47, s2, 0x10003
    v_lshrrev_b32 v32, 3, v0
    v_and_b32 v33, 7, v0
    v_lshrrev_b32 v35, 1, v32
    v_xor_b32 v35, v35, v33
    v_lshlrev_b32 v35, 4, v35
    s_and_b32 s55, s44, 1
    s_lshl_b32 s55, s55, 6
    v_xor_b32 v36, s55, v35
    s_mov_b32 s54, 896
    v_mad_u32_u24 v18, v32, s54, v36
    s_mul_i32 s62, s45, 57344
    s_mul_i32 s54, s44, 7168
    s_add_u32 s62, s62, s54
    s_mul_i32 s54, s47, 28672
    s_add_u32 s61, s62, s54
    s_sub_u32 s62, s62, s54
    s_add_u32 s62, s62, 28672
    s_lshl_b32 s3, s44, 10
    s_lshl_b32 s54, s47, 12
    s_add_u32 s63, s3, s54
    s_sub_u32 s3, s3, s54
    s_add_u32 s3, s3, 4096
    s_and_b32 s46, s2, 7
    s_lshl_b32 s50, s45, 3
    s_add_u32 s50, s50, s46
    s_lshl_b32 s50, s50, 18
    s_lshl_b32 s46, s46, 1
    s_add_u32 s46, s46, s47
    s_lshl_b32 s55, s44, 7
    s_lshl_b32 s54, s46, 9
    s_add_u32 s52, s54, s55
    v_lshlrev_b32 v118, 13, v0
    v_cmp_gt_u32 vcc, 56, v0
    s_nop 1
    v_cndmask_b32 v118, v37, v118, vcc
    v_lshlrev_b32 v116, 7, v0
    v_cmp_gt_u32 vcc, 56, v0
    s_nop 1
    v_cndmask_b32 v116, v37, v116, vcc
    s_mul_i32 s56, s45, 229376
    s_lshl_b32 s54, s46, 9
    s_add_u32 s56, s56, s54
    s_add_u32 s56, s56, s55
    s_bitcmp1_b32 s2, 4
    s_cselect_b32 s56, 0x40000000, s56
    s_waitcnt lgkmcnt(0)
    s_mov_b32 s20, s4
    s_and_b32 s21, s5, 65535
    s_mov_b32 s22, 917504
    s_mov_b32 s23, 131072
    s_mov_b32 s32, s10
    s_and_b32 s33, s11, 65535
    s_mov_b32 s34, 3670016
    s_mov_b32 s35, 131072
    buffer_load_dword v117, v118, s[32:35], s56 offen
    s_add_u32 m0, s63, 0
    s_add_u32 s60, s61, 0
    buffer_load_dwordx4 v18, s[20:23], s60 offen lds
    s_add_u32 m0, s63, 40960
    s_add_u32 s60, s61, 128
    buffer_load_dwordx4 v18, s[20:23], s60 offen lds
    s_add_u32 m0, s63, 81920
    s_add_u32 s60, s61, 256
    buffer_load_dwordx4 v18, s[20:23], s60 offen lds
    s_add_u32 m0, s63, 122880
    s_add_u32 s60, s61, 384
    buffer_load_dwordx4 v18, s[20:23], s60 offen lds
    s_add_u32 m0, s63, 8192
    s_add_u32 s60, s61, 512
    buffer_load_dwordx4 v18, s[20:23], s60 offen lds
    s_add_u32 m0, s63, 49152
    s_add_u32 s60, s61, 640
    buffer_load_dwordx4 v18, s[20:23], s60 offen lds
    s_add_u32 m0, s63, 90112
    s_add_u32 s60, s61, 768
    buffer_load_dwordx4 v18, s[20:23], s60 offen lds
    s_mov_b32 s24, s6
    s_and_b32 s25, s7, 65535
    s_mov_b32 s26, 33554432
    s_mov_b32 s27, 131072
    v_xor_b32 v36, 64, v35
    s_mov_b32 s54, 512
    v_mad_u32_u24 v2, v32, s54, v35
    s_mov_b32 s54, 512
    v_mad_u32_u24 v3, v32, s54, v36
    v_add_u32 v3, 3072, v3
    s_mov_b32 s54, 512
    v_mad_u32_u24 v4, v32, s54, v35
    v_add_u32 v4, 6144, v4
    s_mov_b32 s54, 512
    v_mad_u32_u24 v5, v32, s54, v36
    v_add_u32 v5, 9216, v5
    s_mul_i32 s53, s44, 40960
    s_lshl_b32 s54, s44, 16
    s_add_u32 s48, s50, s54
    s_add_u32 s50, s50, s55
    s_mov_b32 s49, s48
    s_mov_b32 s51, s50
    s_add_u32 m0, s53, 16384
    s_add_u32 s60, s48, 0
    buffer_load_dwordx4 v2, s[24:27], s60 offen nt lds
    buffer_load_dwordx4 v3, s[24:27], s60 offen offset:1024 nt lds
    buffer_load_dwordx4 v4, s[24:27], s60 offen offset:2048 nt lds
    buffer_load_dwordx4 v5, s[24:27], s60 offen offset:3072 nt lds
    s_add_u32 m0, s53, 20480
    s_add_u32 s60, s48, 128
    buffer_load_dwordx4 v2, s[24:27], s60 offen nt lds
    buffer_load_dwordx4 v3, s[24:27], s60 offen offset:1024 nt lds
    buffer_load_dwordx4 v4, s[24:27], s60 offen offset:2048 nt lds
    buffer_load_dwordx4 v5, s[24:27], s60 offen offset:3072 nt lds
    s_mov_b32 s4, s16
    s_and_b32 s5, s17, 65535
    s_mov_b32 s6, 256
    s_mov_b32 s7, 131072
    v_mov_b32 v124, 0
    v_lshlrev_b32 v34, 1, v32
    v_and_b32 v34, 4, v34
    v_xor_b32 v34, v34, v33
    v_lshlrev_b32 v34, 4, v34
    s_mov_b32 s54, 8192
    v_mad_u32_u24 v10, v32, s54, v34
    s_mov_b32 s54, 8192
    v_mad_u32_u24 v11, v32, s54, v34
    v_add_u32 v11, 64512, v11
    s_mov_b32 s54, 8192
    v_mad_u32_u24 v12, v32, s54, v34
    v_add_u32 v12, 129024, v12
    s_mov_b32 s54, 8192
    v_mad_u32_u24 v13, v32, s54, v34
    v_add_u32 v13, 193536, v13
    s_mov_b32 s28, s8
    s_and_b32 s29, s9, 65535
    s_mov_b32 s30, 33554432
    s_mov_b32 s31, 131072
    s_mov_b32 s36, s12
    s_and_b32 s37, s13, 65535
    s_mov_b32 s38, 3670016
    s_mov_b32 s39, 131072
    s_mov_b32 s40, s18
    s_and_b32 s41, s19, 65535
    s_mov_b32 s42, 268435456
    s_mov_b32 s43, 131072
    s_mul_i32 s100, s45, 966656
    s_add_u32 s100, s100, 933888
    s_lshl_b32 s101, s45, 2
    s_add_u32 s101, s101, 128
    s_add_u32 s55, s46, s44
    s_cmp_eq_u32 s55, 0
    s_cselect_b32 s100, s100, 0x40000000
    s_cselect_b32 s101, s101, 0x1000
    v_and_b32 v126, 15, v0
    v_lshlrev_b32 v126, 2, v126
    buffer_load_dword v125, v126, s[40:43], s100 offen sc1
    v_and_b32 v38, 31, v0
    v_lshrrev_b32 v39, 5, v0
    v_bfe_u32 v36, v0, 1, 3
    v_add_u32 v37, 0, v39
    v_xor_b32 v37, v37, v36
    v_lshlrev_b32 v37, 4, v37
    v_lshl_add_u32 v96, v38, 7, v37
    v_add_u32 v19, s53, v96
    v_add_u32 v100, 65536, v96
    v_add_u32 v104, 131072, v96
    v_add_u32 v37, 2, v39
    v_xor_b32 v37, v37, v36
    v_lshlrev_b32 v37, 4, v37
    v_lshl_add_u32 v97, v38, 7, v37
    v_add_u32 v20, s53, v97
    v_add_u32 v101, 65536, v97
    v_add_u32 v105, 131072, v97
    v_add_u32 v37, 4, v39
    v_xor_b32 v37, v37, v36
    v_lshlrev_b32 v37, 4, v37
    v_lshl_add_u32 v98, v38, 7, v37
    v_add_u32 v21, s53, v98
    v_add_u32 v102, 65536, v98
    v_add_u32 v106, 131072, v98
    v_add_u32 v37, 6, v39
    v_xor_b32 v37, v37, v36
    v_lshlrev_b32 v37, 4, v37
    v_lshl_add_u32 v99, v38, 7, v37
    v_add_u32 v22, s53, v99
    v_add_u32 v103, 65536, v99
    v_add_u32 v107, 131072, v99
    s_bitcmp1_b32 s2, 4
    s_cbranch_scc1 L_type1
    s_mov_b32 s54, 512
    v_mad_u32_u24 v6, v32, s54, v34
    s_add_u32 m0, s53, 24576
    s_add_u32 s60, s48, 256
    buffer_load_dwordx4 v2, s[24:27], s60 offen nt lds
    s_mov_b32 s54, 896
    v_mad_u32_u24 v14, v32, s54, v34
    buffer_load_dwordx4 v3, s[24:27], s60 offen offset:1024 nt lds
    s_mov_b32 s54, 512
    v_mad_u32_u24 v7, v32, s54, v34
    buffer_load_dwordx4 v4, s[24:27], s60 offen offset:2048 nt lds
    v_add_u32 v7, 3072, v7
    s_mov_b32 s54, 896
    v_mad_u32_u24 v15, v32, s54, v34
    v_add_u32 v15, 6144, v15
    s_mov_b32 s54, 512
    v_mad_u32_u24 v8, v32, s54, v34
    v_add_u32 v8, 6144, v8
    s_mov_b32 s54, 896
    v_mad_u32_u24 v16, v32, s54, v34
    v_add_u32 v16, 12288, v16
    s_mov_b32 s54, 512
    v_mad_u32_u24 v9, v32, s54, v34
    v_add_u32 v9, 9216, v9
    s_mov_b32 s54, 896
    v_mad_u32_u24 v17, v32, s54, v34
    v_add_u32 v17, 18432, v17
    v_bfe_u32 v32, v0, 2, 2
    v_bfe_u32 v33, v0, 4, 1
    v_lshlrev_b32 v33, 5, v33
    v_and_b32 v34, 1, v0
    v_lshl_add_u32 v33, v34, 4, v33
    v_bfe_u32 v34, v0, 1, 1
    v_lshl_add_u32 v33, v34, 3, v33
    v_bfe_u32 v34, v0, 3, 1
    v_lshl_add_u32 v33, v34, 6, v33
    buffer_load_dwordx4 v5, s[24:27], s60 offen offset:3072 nt lds
    v_lshl_add_u32 v33, v32, 7, v33
    v_add_u32 v33, s53, v33
    v_lshl_add_u32 v23, v39, 10, v33
    v_xor_b32 v24, 64, v23
    v_lshl_add_u32 v25, v39, 9, v33
    v_xor_b32 v26, 64, v25
    v_lshlrev_b32 v28, 4, v0
    v_add_u32 v29, 65536, v28
    v_add_u32 v30, 131072, v28
    v_add_u32 v27, s53, v28
    v_lshlrev_b32 v31, 2, v0
    v_add_u32 v31, s53, v31
    s_mul_i32 s59, s46, 229376
    s_lshl_b32 s55, s44, 7
    s_add_u32 s57, s59, s55
    s_add_u32 s54, s44, 0
    s_and_b32 s54, s54, 3
    s_mul_i32 s54, s54, 57344
    s_add_u32 s92, s57, s54
    s_add_u32 s96, s92, 512
    s_cmp_eq_u32 s44, 3
    s_cselect_b32 s96, 0x40000000, s96
    s_add_u32 s54, s44, 1
    s_and_b32 s54, s54, 3
    s_mul_i32 s55, s54, 40960
    v_add_u32 v121, s55, v28
    s_mul_i32 s54, s54, 57344
    s_add_u32 s93, s57, s54
    s_add_u32 s97, s93, 512
    s_cmp_eq_u32 s44, 3
    s_cselect_b32 s97, 0x40000000, s97
    s_add_u32 s54, s44, 2
    s_and_b32 s54, s54, 3
    s_mul_i32 s55, s54, 40960
    v_add_u32 v122, s55, v28
    s_add_u32 m0, s53, 28672
    s_add_u32 s60, s48, 384
    buffer_load_dwordx4 v2, s[24:27], s60 offen nt lds
    s_mul_i32 s54, s54, 57344
    s_add_u32 s94, s57, s54
    s_add_u32 s98, s94, 512
    s_cmp_eq_u32 s44, 3
    s_cselect_b32 s98, 0x40000000, s98
    s_add_u32 s54, s44, 3
    s_and_b32 s54, s54, 3
    s_mul_i32 s55, s54, 40960
    v_add_u32 v123, s55, v28
    s_mul_i32 s54, s54, 57344
    s_add_u32 s95, s57, s54
    s_add_u32 s99, s95, 512
    s_cmp_eq_u32 s44, 3
    s_cselect_b32 s99, 0x40000000, s99
    s_lshr_b32 s54, s45, 1
    s_lshl_b32 s54, s54, 2
    s_add_u32 s54, s54, s44
    s_mul_i32 s54, s54, 7168
    s_add_u32 s59, s59, s54
    s_mul_i32 s56, s45, 966656
    s_lshl_b32 s54, s46, 10
    s_add_u32 s56, s56, s54
    s_add_u32 s56, s56, 16384
    s_lshl_b32 s54, s44, 17
    s_add_u32 s56, s56, s54
    s_add_u32 s57, s56, 524288
    s_cmp_eq_u32 s44, 3
    s_cselect_b32 s57, 0x40000000, s57
    s_mov_b32 s58, 1035512379
    s_mov_b32 s8, s14
    s_and_b32 s9, s15, 65535
    s_mov_b32 s10, 917504
    s_mov_b32 s11, 131072
    s_mul_i32 s12, s45, 57344
    buffer_load_dwordx4 v3, s[24:27], s60 offen offset:1024 nt lds
    buffer_load_dwordx4 v4, s[24:27], s60 offen offset:2048 nt lds
    buffer_load_dwordx4 v5, s[24:27], s60 offen offset:3072 nt lds
    s_waitcnt vmcnt(13)
    ds_read_b128 a[0:3], v19 offset:16384
    ds_read_b128 a[4:7], v20 offset:16384
    ds_read_b128 a[8:11], v21 offset:16384
    ds_read_b128 a[12:15], v22 offset:16384
    s_add_u32 m0, s53, 32768
    s_add_u32 s60, s49, 16384
    buffer_load_dwordx4 v2, s[24:27], s60 offen nt lds
    buffer_load_dwordx4 v3, s[24:27], s60 offen offset:1024 nt lds
    s_waitcnt lgkmcnt(0)
    buffer_load_dwordx4 v4, s[24:27], s60 offen offset:2048 nt lds
    buffer_load_dwordx4 v5, s[24:27], s60 offen offset:3072 nt lds
    s_waitcnt vmcnt(13)
    ds_read_b128 a[16:19], v19 offset:20480
    ds_read_b128 a[20:23], v20 offset:20480
    ds_read_b128 a[24:27], v21 offset:20480
    ds_read_b128 a[28:31], v22 offset:20480
    s_add_u32 m0, s53, 36864
    s_add_u32 s60, s49, 16512
    buffer_load_dwordx4 v2, s[24:27], s60 offen nt lds
    buffer_load_dwordx4 v3, s[24:27], s60 offen offset:1024 nt lds
    s_waitcnt lgkmcnt(0)
    buffer_load_dwordx4 v4, s[24:27], s60 offen offset:2048 nt lds
    buffer_load_dwordx4 v5, s[24:27], s60 offen offset:3072 nt lds
    s_waitcnt vmcnt(12)
    ds_read_b128 a[32:35], v19 offset:24576
    ds_read_b128 a[36:39], v20 offset:24576
    ds_read_b128 a[40:43], v21 offset:24576
    ds_read_b128 a[44:47], v22 offset:24576
    s_add_u32 m0, s53, 16384
    s_add_u32 s60, s49, 16640
    buffer_load_dwordx4 v2, s[24:27], s60 offen nt lds
    buffer_load_dwordx4 v3, s[24:27], s60 offen offset:1024 nt lds
    s_waitcnt lgkmcnt(0)
    buffer_load_dwordx4 v4, s[24:27], s60 offen offset:2048 nt lds
    buffer_load_dwordx4 v5, s[24:27], s60 offen offset:3072 nt lds
    s_waitcnt vmcnt(12)
    ds_read_b128 a[48:51], v19 offset:28672
    ds_read_b128 a[52:55], v20 offset:28672
    ds_read_b128 a[56:59], v21 offset:28672
    ds_read_b128 a[60:63], v22 offset:28672
    s_add_u32 m0, s53, 20480
    s_add_u32 s60, s49, 16768
    buffer_load_dwordx4 v2, s[24:27], s60 offen nt lds
    buffer_load_dwordx4 v3, s[24:27], s60 offen offset:1024 nt lds
    s_waitcnt lgkmcnt(0)
    buffer_load_dwordx4 v4, s[24:27], s60 offen offset:2048 nt lds
    buffer_load_dwordx4 v5, s[24:27], s60 offen offset:3072 nt lds
    s_waitcnt vmcnt(12)
    ds_read_b128 a[64:67], v19 offset:32768
    ds_read_b128 a[68:71], v20 offset:32768
    ds_read_b128 a[72:75], v21 offset:32768
    ds_read_b128 a[76:79], v22 offset:32768
    s_add_u32 m0, s3, 0
    s_add_u32 s60, s62, 0
    buffer_load_dwordx4 v18, s[20:23], s60 offen lds
    s_add_u32 m0, s3, 40960
    s_add_u32 s60, s62, 128
    buffer_load_dwordx4 v18, s[20:23], s60 offen lds
    s_waitcnt lgkmcnt(0)
    s_add_u32 m0, s3, 81920
    s_add_u32 s60, s62, 256
    buffer_load_dwordx4 v18, s[20:23], s60 offen lds
    s_add_u32 m0, s3, 122880
    s_add_u32 s60, s62, 384
    buffer_load_dwordx4 v18, s[20:23], s60 offen lds
    s_waitcnt vmcnt(12)
    ds_read_b128 a[80:83], v19 offset:36864
    ds_read_b128 a[84:87], v20 offset:36864
    ds_read_b128 a[88:91], v21 offset:36864
    ds_read_b128 a[92:95], v22 offset:36864
    s_add_u32 m0, s3, 8192
    s_add_u32 s60, s62, 512
    buffer_load_dwordx4 v18, s[20:23], s60 offen lds
    s_add_u32 m0, s3, 49152
    s_add_u32 s60, s62, 640
    buffer_load_dwordx4 v18, s[20:23], s60 offen lds
    s_waitcnt lgkmcnt(0)
    s_add_u32 m0, s3, 90112
    s_add_u32 s60, s62, 768
    buffer_load_dwordx4 v18, s[20:23], s60 offen lds
    s_add_u32 m0, s53, 24576
    s_add_u32 s60, s52, 0
    buffer_load_dwordx4 v10, s[32:35], s60 offen lds
    s_waitcnt vmcnt(12)
    ds_read_b128 a[96:99], v19 offset:16384
    ds_read_b128 a[100:103], v20 offset:16384
    ds_read_b128 a[104:107], v21 offset:16384
    ds_read_b128 a[108:111], v22 offset:16384
    buffer_load_dwordx4 v11, s[32:35], s60 offen offset:1024 lds
    buffer_load_dwordx4 v12, s[32:35], s60 offen offset:2048 lds
    s_waitcnt lgkmcnt(0)
    buffer_load_dwordx4 v13, s[32:35], s60 offen offset:3072 lds
    s_add_u32 m0, s53, 28672
    s_add_u32 s60, s52, 262144
    buffer_load_dwordx4 v10, s[32:35], s60 offen lds
    s_waitcnt vmcnt(12)
    ds_read_b128 a[112:115], v19 offset:20480
    ds_read_b128 a[116:119], v20 offset:20480
    ds_read_b128 a[120:123], v21 offset:20480
    ds_read_b128 a[124:127], v22 offset:20480
    buffer_load_dwordx4 v11, s[32:35], s60 offen offset:1024 lds
    buffer_load_dwordx4 v12, s[32:35], s60 offen offset:2048 lds
    buffer_load_dwordx4 v13, s[32:35], s60 offen offset:3072 lds
    s_add_u32 m0, s53, 32768
    s_add_u32 s60, s52, 524288
    buffer_load_dwordx4 v10, s[32:35], s60 offen lds
    buffer_load_dwordx4 v11, s[32:35], s60 offen offset:1024 lds
    s_waitcnt lgkmcnt(0)
    buffer_load_dwordx4 v12, s[32:35], s60 offen offset:2048 lds
    s_waitcnt vmcnt(11)
    s_barrier
    v_lshrrev_b32 v125, v0, v125
    v_and_b32 v125, 1, v125
    v_cmp_eq_u32 vcc, 0, v125
    s_nop 3
    s_and_b32 s100, vcc_lo, 0xffff
    s_or_b32 s100, s100, 65536
    v_mov_b32 v125, s100
    buffer_store_dword v125, v124, s[4:7], s101 offen sc1
    ds_read_b128 v[64:67], v96 offset:0
    buffer_load_dwordx4 v13, s[32:35], s60 offen offset:3072 lds
    ds_read_b128 v[68:71], v96 offset:4096
    s_add_u32 m0, s53, 36864
    s_add_u32 s60, s52, 786432
    buffer_load_dwordx4 v10, s[32:35], s60 offen lds
    s_waitcnt vmcnt(10)
    ds_read_b64_tr_b16 a[128:129], v23 offset:24576
    ds_read_b128 v[72:75], v97 offset:0
    buffer_load_dwordx4 v11, s[32:35], s60 offen offset:1024 lds
    ds_read_b64_tr_b16 a[130:131], v23 offset:25088
    ds_read_b128 v[76:79], v97 offset:4096
    buffer_load_dwordx4 v12, s[32:35], s60 offen offset:2048 lds
    ds_read_b64_tr_b16 a[132:133], v24 offset:24576
    ds_read_b64_tr_b16 a[134:135], v24 offset:25088
    ds_read_b64_tr_b16 a[136:137], v23 offset:26624
    ds_read_b64_tr_b16 a[138:139], v23 offset:27136
    ds_read_b64_tr_b16 a[140:141], v24 offset:26624
    ds_read_b64_tr_b16 a[142:143], v24 offset:27136
    s_waitcnt lgkmcnt(7)
    v_mfma_f32_32x32x16_bf16 v[128:143], a[128:131], v[64:67], 0
    buffer_load_dwordx4 v13, s[32:35], s60 offen offset:3072 lds
    ds_read_b128 v[80:83], v98 offset:0
    v_mfma_f32_32x32x16_bf16 v[144:159], a[128:131], v[68:71], 0
    s_add_u32 m0, s53, 16384
    s_add_u32 s60, s52, 1048576
    buffer_load_dwordx4 v10, s[32:35], s60 offen lds
    ds_read_b128 v[84:87], v98 offset:4096
    s_waitcnt lgkmcnt(6)
    v_mfma_f32_32x32x16_bf16 v[160:175], a[132:135], v[64:67], 0
    buffer_load_dwordx4 v11, s[32:35], s60 offen offset:1024 lds
    ds_read_b128 v[88:91], v99 offset:0
    buffer_load_dwordx4 v12, s[32:35], s60 offen offset:2048 lds
    s_waitcnt vmcnt(12)
    ds_read_b64_tr_b16 a[144:145], v23 offset:28672
    ds_read_b64_tr_b16 a[146:147], v23 offset:29184
    ds_read_b64_tr_b16 a[148:149], v24 offset:28672
    ds_read_b64_tr_b16 a[150:151], v24 offset:29184
    ds_read_b64_tr_b16 a[152:153], v23 offset:30720
    ds_read_b64_tr_b16 a[154:155], v23 offset:31232
    ds_read_b64_tr_b16 a[156:157], v24 offset:30720
    ds_read_b64_tr_b16 a[158:159], v24 offset:31232
    v_mfma_f32_32x32x16_bf16 v[176:191], a[132:135], v[68:71], 0
    buffer_load_dwordx4 v13, s[32:35], s60 offen offset:3072 lds
    ds_read_b128 v[92:95], v99 offset:4096
    s_waitcnt lgkmcnt(14)
    v_mfma_f32_32x32x16_bf16 v[128:143], a[136:139], v[72:75], v[128:143]
    s_waitcnt lgkmcnt(12)
    s_add_u32 m0, s53, 20480
    s_add_u32 s60, s52, 1310720
    buffer_load_dwordx4 v10, s[32:35], s60 offen lds
    v_mfma_f32_32x32x16_bf16 v[144:159], a[136:139], v[76:79], v[144:159]
    buffer_load_dwordx4 v11, s[32:35], s60 offen offset:1024 lds
    v_mfma_f32_32x32x16_bf16 v[160:175], a[140:143], v[72:75], v[160:175]
    buffer_load_dwordx4 v12, s[32:35], s60 offen offset:2048 lds
    v_mfma_f32_32x32x16_bf16 v[176:191], a[140:143], v[76:79], v[176:191]
    s_waitcnt lgkmcnt(7)
    v_mfma_f32_32x32x16_bf16 v[128:143], a[144:147], v[80:83], v[128:143]
    s_waitcnt lgkmcnt(1)
    ds_read_b128 v[64:67], v96 offset:40960
    v_mfma_f32_32x32x16_bf16 v[144:159], a[144:147], v[84:87], v[144:159]
    ds_read_b128 v[68:71], v96 offset:45056
    v_mfma_f32_32x32x16_bf16 v[160:175], a[148:151], v[80:83], v[160:175]
    buffer_load_dwordx4 v13, s[32:35], s60 offen offset:3072 lds
    s_waitcnt vmcnt(12)
    ds_read_b64_tr_b16 a[160:161], v23 offset:32768
    ds_read_b64_tr_b16 a[162:163], v23 offset:33280
    ds_read_b128 v[72:75], v97 offset:40960
    ds_read_b64_tr_b16 a[164:165], v24 offset:32768
    ds_read_b64_tr_b16 a[166:167], v24 offset:33280
    ds_read_b64_tr_b16 a[168:169], v23 offset:34816
    ds_read_b64_tr_b16 a[170:171], v23 offset:35328
    ds_read_b64_tr_b16 a[172:173], v24 offset:34816
    ds_read_b64_tr_b16 a[174:175], v24 offset:35328
    v_mfma_f32_32x32x16_bf16 v[176:191], a[148:151], v[84:87], v[176:191]
    s_add_u32 m0, s53, 24576
    s_add_u32 s60, s52, 1572864
    buffer_load_dwordx4 v10, s[32:35], s60 offen lds
    ds_read_b128 v[76:79], v97 offset:45056
    v_mfma_f32_32x32x16_bf16 v[128:143], a[152:155], v[88:91], v[128:143]
    buffer_load_dwordx4 v11, s[32:35], s60 offen offset:1024 lds
    s_waitcnt lgkmcnt(12)
    v_mfma_f32_32x32x16_bf16 v[144:159], a[152:155], v[92:95], v[144:159]
    buffer_load_dwordx4 v12, s[32:35], s60 offen offset:2048 lds
    v_mfma_f32_32x32x16_bf16 v[160:175], a[156:159], v[88:91], v[160:175]
    v_mfma_f32_32x32x16_bf16 v[176:191], a[156:159], v[92:95], v[176:191]
    buffer_load_dwordx4 v13, s[32:35], s60 offen offset:3072 lds
    s_waitcnt vmcnt(12)
    ds_read_b64_tr_b16 a[176:177], v23 offset:36864
    ds_read_b64_tr_b16 a[178:179], v23 offset:37376
    s_waitcnt lgkmcnt(10)
    v_mfma_f32_32x32x16_bf16 v[128:143], a[160:163], v[64:67], v[128:143]
    s_waitcnt lgkmcnt(3)
    s_add_u32 m0, s53, 28672
    s_add_u32 s60, s52, 1835008
    buffer_load_dwordx4 v10, s[32:35], s60 offen lds
    ds_read_b64_tr_b16 a[180:181], v24 offset:36864
    ds_read_b64_tr_b16 a[182:183], v24 offset:37376
    ds_read_b128 v[80:83], v98 offset:40960
    v_mfma_f32_32x32x16_bf16 v[144:159], a[160:163], v[68:71], v[144:159]
    buffer_load_dwordx4 v11, s[32:35], s60 offen offset:1024 lds
    ds_read_b64_tr_b16 a[184:185], v23 offset:38912
    ds_read_b64_tr_b16 a[186:187], v23 offset:39424
    ds_read_b128 v[84:87], v98 offset:45056
    v_mfma_f32_32x32x16_bf16 v[160:175], a[164:167], v[64:67], v[160:175]
    buffer_load_dwordx4 v12, s[32:35], s60 offen offset:2048 lds
    ds_read_b64_tr_b16 a[188:189], v24 offset:38912
    ds_read_b64_tr_b16 a[190:191], v24 offset:39424
    ds_read_b128 v[88:91], v99 offset:40960
    v_mfma_f32_32x32x16_bf16 v[176:191], a[164:167], v[68:71], v[176:191]
    buffer_load_dwordx4 v13, s[32:35], s60 offen offset:3072 lds
    s_waitcnt vmcnt(12)
    ds_read_b64_tr_b16 a[192:193], v23 offset:16384
    ds_read_b64_tr_b16 a[194:195], v23 offset:16896
    ds_read_b128 v[92:95], v99 offset:45056
    v_mfma_f32_32x32x16_bf16 v[128:143], a[168:171], v[72:75], v[128:143]
    ds_read_b64_tr_b16 a[196:197], v24 offset:16384
    ds_read_b64_tr_b16 a[198:199], v24 offset:16896
    s_waitcnt lgkmcnt(14)
    v_mfma_f32_32x32x16_bf16 v[144:159], a[168:171], v[76:79], v[144:159]
    s_add_u32 m0, s53, 32768
    s_add_u32 s60, s52, 2097152
    buffer_load_dwordx4 v10, s[32:35], s60 offen lds
    ds_read_b64_tr_b16 a[200:201], v23 offset:18432
    ds_read_b64_tr_b16 a[202:203], v23 offset:18944
    v_mfma_f32_32x32x16_bf16 v[160:175], a[172:175], v[72:75], v[160:175]
    buffer_load_dwordx4 v11, s[32:35], s60 offen offset:1024 lds
    ds_read_b64_tr_b16 a[204:205], v24 offset:18432
    ds_read_b64_tr_b16 a[206:207], v24 offset:18944
    v_mfma_f32_32x32x16_bf16 v[176:191], a[172:175], v[76:79], v[176:191]
    buffer_load_dwordx4 v12, s[32:35], s60 offen offset:2048 lds
    s_waitcnt lgkmcnt(14)
    v_mfma_f32_32x32x16_bf16 v[128:143], a[176:179], v[80:83], v[128:143]
    s_waitcnt lgkmcnt(10)
    buffer_load_dwordx4 v13, s[32:35], s60 offen offset:3072 lds
    s_waitcnt vmcnt(12)
    ds_read_b64_tr_b16 a[208:209], v23 offset:20480
    ds_read_b64_tr_b16 a[210:211], v23 offset:20992
    ds_read_b128 v[64:67], v100 offset:16384
    v_mfma_f32_32x32x16_bf16 v[144:159], a[176:179], v[84:87], v[144:159]
    ds_read_b64_tr_b16 a[212:213], v24 offset:20480
    ds_read_b64_tr_b16 a[214:215], v24 offset:20992
    ds_read_b128 v[68:71], v100 offset:20480
    v_mfma_f32_32x32x16_bf16 v[160:175], a[180:183], v[80:83], v[160:175]
    s_add_u32 m0, s53, 36864
    s_add_u32 s60, s52, 2359296
    buffer_load_dwordx4 v10, s[32:35], s60 offen lds
    ds_read_b64_tr_b16 a[216:217], v23 offset:22528
    ds_read_b64_tr_b16 a[218:219], v23 offset:23040
    ds_read_b128 v[72:75], v101 offset:16384
    ds_read_b64_tr_b16 a[220:221], v24 offset:22528
    ds_read_b64_tr_b16 a[222:223], v24 offset:23040
    v_mfma_f32_32x32x16_bf16 v[176:191], a[180:183], v[84:87], v[176:191]
    buffer_load_dwordx4 v11, s[32:35], s60 offen offset:1024 lds
    ds_read_b128 v[76:79], v101 offset:20480
    s_waitcnt lgkmcnt(14)
    v_mfma_f32_32x32x16_bf16 v[128:143], a[184:187], v[88:91], v[128:143]
    s_waitcnt lgkmcnt(12)
    buffer_load_dwordx4 v12, s[32:35], s60 offen offset:2048 lds
    v_mfma_f32_32x32x16_bf16 v[144:159], a[184:187], v[92:95], v[144:159]
    buffer_load_dwordx4 v13, s[32:35], s60 offen offset:3072 lds
    s_waitcnt vmcnt(12)
    ds_read_b64_tr_b16 a[224:225], v23 offset:24576
    ds_read_b64_tr_b16 a[226:227], v23 offset:25088
    v_mfma_f32_32x32x16_bf16 v[160:175], a[188:191], v[88:91], v[160:175]
    s_add_u32 m0, s53, 16384
    s_add_u32 s60, s52, 2621440
    buffer_load_dwordx4 v10, s[32:35], s60 offen lds
    ds_read_b64_tr_b16 a[228:229], v24 offset:24576
    ds_read_b64_tr_b16 a[230:231], v24 offset:25088
    v_mfma_f32_32x32x16_bf16 v[176:191], a[188:191], v[92:95], v[176:191]
    buffer_load_dwordx4 v11, s[32:35], s60 offen offset:1024 lds
    ds_read_b64_tr_b16 a[232:233], v23 offset:26624
    ds_read_b64_tr_b16 a[234:235], v23 offset:27136
    s_waitcnt lgkmcnt(14)
    v_mfma_f32_32x32x16_bf16 v[128:143], a[192:195], v[64:67], v[128:143]
    s_waitcnt lgkmcnt(7)
    ds_read_b64_tr_b16 a[236:237], v24 offset:26624
    ds_read_b64_tr_b16 a[238:239], v24 offset:27136
    ds_read_b128 v[80:83], v102 offset:16384
    v_mfma_f32_32x32x16_bf16 v[144:159], a[192:195], v[68:71], v[144:159]
    buffer_load_dwordx4 v12, s[32:35], s60 offen offset:2048 lds
    ds_read_b128 v[84:87], v102 offset:20480
    v_mfma_f32_32x32x16_bf16 v[160:175], a[196:199], v[64:67], v[160:175]
    buffer_load_dwordx4 v13, s[32:35], s60 offen offset:3072 lds
    s_waitcnt vmcnt(12)
    ds_read_b64_tr_b16 a[240:241], v23 offset:28672
    ds_read_b64_tr_b16 a[242:243], v23 offset:29184
    ds_read_b128 v[88:91], v103 offset:16384
    ds_read_b64_tr_b16 a[244:245], v24 offset:28672
    ds_read_b64_tr_b16 a[246:247], v24 offset:29184
    ds_read_b64_tr_b16 a[248:249], v23 offset:30720
    ds_read_b64_tr_b16 a[250:251], v23 offset:31232
    ds_read_b64_tr_b16 a[252:253], v24 offset:30720
    ds_read_b64_tr_b16 a[254:255], v24 offset:31232
    v_mfma_f32_32x32x16_bf16 v[176:191], a[196:199], v[68:71], v[176:191]
    s_add_u32 m0, s53, 20480
    s_add_u32 s60, s52, 2883584
    buffer_load_dwordx4 v10, s[32:35], s60 offen lds
    ds_read_b128 v[92:95], v103 offset:20480
    v_mfma_f32_32x32x16_bf16 v[128:143], a[200:203], v[72:75], v[128:143]
    buffer_load_dwordx4 v11, s[32:35], s60 offen offset:1024 lds
    s_waitcnt lgkmcnt(14)
    v_mfma_f32_32x32x16_bf16 v[144:159], a[200:203], v[76:79], v[144:159]
    s_waitcnt lgkmcnt(12)
    buffer_load_dwordx4 v12, s[32:35], s60 offen offset:2048 lds
    v_mfma_f32_32x32x16_bf16 v[160:175], a[204:207], v[72:75], v[160:175]
    buffer_load_dwordx4 v13, s[32:35], s60 offen offset:3072 lds
    s_waitcnt vmcnt(12)
    ds_read_b64_tr_b16 a[128:129], v23 offset:32768
    ds_read_b64_tr_b16 a[130:131], v23 offset:33280
    v_mfma_f32_32x32x16_bf16 v[176:191], a[204:207], v[76:79], v[176:191]
    ds_read_b64_tr_b16 a[132:133], v24 offset:32768
    ds_read_b64_tr_b16 a[134:135], v24 offset:33280
    s_waitcnt lgkmcnt(14)
    v_mfma_f32_32x32x16_bf16 v[128:143], a[208:211], v[80:83], v[128:143]
    s_waitcnt lgkmcnt(5)
    s_add_u32 m0, s53, 24576
    s_add_u32 s60, s52, 3145728
    buffer_load_dwordx4 v10, s[32:35], s60 offen lds
    ds_read_b64_tr_b16 a[136:137], v23 offset:34816
    ds_read_b64_tr_b16 a[138:139], v23 offset:35328
    ds_read_b128 v[64:67], v100 offset:57344
    v_mfma_f32_32x32x16_bf16 v[144:159], a[208:211], v[84:87], v[144:159]
    buffer_load_dwordx4 v11, s[32:35], s60 offen offset:1024 lds
    ds_read_b64_tr_b16 a[140:141], v24 offset:34816
    ds_read_b64_tr_b16 a[142:143], v24 offset:35328
    ds_read_b128 v[68:71], v100 offset:61440
    v_mfma_f32_32x32x16_bf16 v[160:175], a[212:215], v[80:83], v[160:175]
    buffer_load_dwordx4 v12, s[32:35], s60 offen offset:2048 lds
    ds_read_b128 v[72:75], v101 offset:57344
    v_mfma_f32_32x32x16_bf16 v[176:191], a[212:215], v[84:87], v[176:191]
    buffer_load_dwordx4 v13, s[32:35], s60 offen offset:3072 lds
    s_waitcnt vmcnt(12)
    ds_read_b64_tr_b16 a[144:145], v23 offset:36864
    ds_read_b64_tr_b16 a[146:147], v23 offset:37376
    ds_read_b128 v[76:79], v101 offset:61440
    v_mfma_f32_32x32x16_bf16 v[128:143], a[216:219], v[88:91], v[128:143]
    ds_read_b64_tr_b16 a[148:149], v24 offset:36864
    ds_read_b64_tr_b16 a[150:151], v24 offset:37376
    s_waitcnt lgkmcnt(14)
    v_mfma_f32_32x32x16_bf16 v[144:159], a[216:219], v[92:95], v[144:159]
    s_add_u32 m0, s53, 28672
    s_add_u32 s60, s52, 3407872
    buffer_load_dwordx4 v10, s[32:35], s60 offen lds
    ds_read_b64_tr_b16 a[152:153], v23 offset:38912
    ds_read_b64_tr_b16 a[154:155], v23 offset:39424
    v_mfma_f32_32x32x16_bf16 v[160:175], a[220:223], v[88:91], v[160:175]
    buffer_load_dwordx4 v11, s[32:35], s60 offen offset:1024 lds
    ds_read_b64_tr_b16 a[156:157], v24 offset:38912
    ds_read_b64_tr_b16 a[158:159], v24 offset:39424
    v_mfma_f32_32x32x16_bf16 v[176:191], a[220:223], v[92:95], v[176:191]
    s_waitcnt lgkmcnt(11)
    buffer_load_dwordx4 v12, s[32:35], s60 offen offset:2048 lds
    v_mfma_f32_32x32x16_bf16 v[128:143], a[224:227], v[64:67], v[128:143]
    buffer_load_dwordx4 v13, s[32:35], s60 offen offset:3072 lds
    s_waitcnt vmcnt(12)
    ds_read_b64_tr_b16 a[160:161], v23 offset:16384
    ds_read_b64_tr_b16 a[162:163], v23 offset:16896
    ds_read_b128 v[80:83], v102 offset:57344
    s_waitcnt lgkmcnt(13)
    v_mfma_f32_32x32x16_bf16 v[144:159], a[224:227], v[68:71], v[144:159]
    ds_read_b64_tr_b16 a[164:165], v24 offset:16384
    ds_read_b64_tr_b16 a[166:167], v24 offset:16896
    ds_read_b128 v[84:87], v102 offset:61440
    v_mfma_f32_32x32x16_bf16 v[160:175], a[228:231], v[64:67], v[160:175]
    ds_read_b64_tr_b16 a[168:169], v23 offset:18432
    ds_read_b64_tr_b16 a[170:171], v23 offset:18944
    ds_read_b128 v[88:91], v103 offset:57344
    ds_read_b64_tr_b16 a[172:173], v24 offset:18432
    ds_read_b64_tr_b16 a[174:175], v24 offset:18944
    v_mfma_f32_32x32x16_bf16 v[176:191], a[228:231], v[68:71], v[176:191]
    ds_read_b128 v[92:95], v103 offset:61440
    s_waitcnt lgkmcnt(14)
    v_mfma_f32_32x32x16_bf16 v[128:143], a[232:235], v[72:75], v[128:143]
    s_waitcnt lgkmcnt(12)
    v_mfma_f32_32x32x16_bf16 v[144:159], a[232:235], v[76:79], v[144:159]
    v_mfma_f32_32x32x16_bf16 v[160:175], a[236:239], v[72:75], v[160:175]
    s_waitcnt vmcnt(8)
    ds_read_b64_tr_b16 a[176:177], v23 offset:20480
    ds_read_b64_tr_b16 a[178:179], v23 offset:20992
    v_mfma_f32_32x32x16_bf16 v[176:191], a[236:239], v[76:79], v[176:191]
    ds_read_b64_tr_b16 a[180:181], v24 offset:20480
    ds_read_b64_tr_b16 a[182:183], v24 offset:20992
    s_waitcnt lgkmcnt(13)
    v_mfma_f32_32x32x16_bf16 v[128:143], a[240:243], v[80:83], v[128:143]
    s_waitcnt lgkmcnt(5)
    s_add_u32 m0, s53, 32768
    s_add_u32 s60, s48, 32768
    buffer_load_dwordx4 v2, s[24:27], s60 offen nt lds
    ds_read_b64_tr_b16 a[184:185], v23 offset:22528
    ds_read_b64_tr_b16 a[186:187], v23 offset:23040
    ds_read_b128 v[64:67], v96 offset:8192
    v_mfma_f32_32x32x16_bf16 v[144:159], a[240:243], v[84:87], v[144:159]
    buffer_load_dwordx4 v3, s[24:27], s60 offen offset:1024 nt lds
    ds_read_b64_tr_b16 a[188:189], v24 offset:22528
    ds_read_b64_tr_b16 a[190:191], v24 offset:23040
    ds_read_b128 v[68:71], v96 offset:12288
    v_mfma_f32_32x32x16_bf16 v[160:175], a[244:247], v[80:83], v[160:175]
    buffer_load_dwordx4 v4, s[24:27], s60 offen offset:2048 nt lds
    s_waitcnt vmcnt(7)
    ds_read_b64_tr_b16 a[192:193], v23 offset:24576
    ds_read_b64_tr_b16 a[194:195], v23 offset:25088
    ds_read_b128 v[72:75], v97 offset:8192
    ds_read_b64_tr_b16 a[196:197], v24 offset:24576
    ds_read_b64_tr_b16 a[198:199], v24 offset:25088
    ds_read_b64_tr_b16 a[200:201], v23 offset:26624
    ds_read_b64_tr_b16 a[202:203], v23 offset:27136
    ds_read_b64_tr_b16 a[204:205], v24 offset:26624
    ds_read_b64_tr_b16 a[206:207], v24 offset:27136
    v_mfma_f32_32x32x16_bf16 v[176:191], a[244:247], v[84:87], v[176:191]
    buffer_load_dwordx4 v5, s[24:27], s60 offen offset:3072 nt lds
    ds_read_b128 v[76:79], v97 offset:12288
    v_mfma_f32_32x32x16_bf16 v[128:143], a[248:251], v[88:91], v[128:143]
    s_waitcnt lgkmcnt(14)
    v_mfma_f32_32x32x16_bf16 v[144:159], a[248:251], v[92:95], v[144:159]
    v_mfma_f32_32x32x16_bf16 v[160:175], a[252:255], v[88:91], v[160:175]
    s_waitcnt lgkmcnt(11)
    s_add_u32 m0, s53, 36864
    s_add_u32 s60, s48, 32896
    buffer_load_dwordx4 v2, s[24:27], s60 offen nt lds
    s_waitcnt vmcnt(5)
    ds_read_b64_tr_b16 a[208:209], v23 offset:28672
    ds_read_b64_tr_b16 a[210:211], v23 offset:29184
    v_mfma_f32_32x32x16_bf16 v[176:191], a[252:255], v[92:95], v[176:191]
    buffer_load_dwordx4 v3, s[24:27], s60 offen offset:1024 nt lds
    ds_read_b64_tr_b16 a[212:213], v24 offset:28672
    ds_read_b64_tr_b16 a[214:215], v24 offset:29184
    v_mfma_f32_32x32x16_bf16 v[128:143], a[128:131], v[64:67], v[128:143]
    s_waitcnt lgkmcnt(5)
    buffer_load_dwordx4 v4, s[24:27], s60 offen offset:2048 nt lds
    ds_read_b64_tr_b16 a[216:217], v23 offset:30720
    ds_read_b64_tr_b16 a[218:219], v23 offset:31232
    ds_read_b128 v[80:83], v98 offset:8192
    s_barrier
    v_mfma_f32_32x32x16_bf16 v[144:159], a[128:131], v[68:71], v[144:159]
    buffer_load_dwordx4 v5, s[24:27], s60 offen offset:3072 nt lds
    ds_read_b64_tr_b16 a[220:221], v24 offset:30720
    ds_read_b64_tr_b16 a[222:223], v24 offset:31232
    ds_read_b128 v[84:87], v98 offset:12288
    v_mfma_f32_32x32x16_bf16 v[160:175], a[132:135], v[64:67], v[160:175]
    s_add_u32 m0, s53, 16384
    s_add_u32 s60, s48, 33024
    buffer_load_dwordx4 v2, s[24:27], s60 offen nt lds
    ds_read_b128 v[88:91], v99 offset:8192
    v_mfma_f32_32x32x16_bf16 v[176:191], a[132:135], v[68:71], v[176:191]
    buffer_load_dwordx4 v3, s[24:27], s60 offen offset:1024 nt lds
    ds_read_b128 v[92:95], v99 offset:12288
    v_mfma_f32_32x32x16_bf16 v[128:143], a[136:139], v[72:75], v[128:143]
    buffer_load_dwordx4 v4, s[24:27], s60 offen offset:2048 nt lds
    s_waitcnt lgkmcnt(12)
    v_mfma_f32_32x32x16_bf16 v[144:159], a[136:139], v[76:79], v[144:159]
    buffer_load_dwordx4 v5, s[24:27], s60 offen offset:3072 nt lds
    v_mfma_f32_32x32x16_bf16 v[160:175], a[140:143], v[72:75], v[160:175]
    v_mfma_f32_32x32x16_bf16 v[176:191], a[140:143], v[76:79], v[176:191]
    s_waitcnt lgkmcnt(3)
    v_mfma_f32_32x32x16_bf16 v[128:143], a[144:147], v[80:83], v[128:143]
    ds_read_b128 v[64:67], v96 offset:49152
    s_waitcnt lgkmcnt(3)
    v_mfma_f32_32x32x16_bf16 v[144:159], a[144:147], v[84:87], v[144:159]
    ds_read_b128 v[68:71], v96 offset:53248
    v_mfma_f32_32x32x16_bf16 v[160:175], a[148:151], v[80:83], v[160:175]
    ds_read_b128 v[72:75], v97 offset:49152
    v_mfma_f32_32x32x16_bf16 v[176:191], a[148:151], v[84:87], v[176:191]
    ds_read_b128 v[76:79], v97 offset:53248
    s_waitcnt lgkmcnt(5)
    v_mfma_f32_32x32x16_bf16 v[128:143], a[152:155], v[88:91], v[128:143]
    s_waitcnt lgkmcnt(4)
    v_mfma_f32_32x32x16_bf16 v[144:159], a[152:155], v[92:95], v[144:159]
    v_mfma_f32_32x32x16_bf16 v[160:175], a[156:159], v[88:91], v[160:175]
    v_mfma_f32_32x32x16_bf16 v[176:191], a[156:159], v[92:95], v[176:191]
    s_waitcnt lgkmcnt(3)
    v_mfma_f32_32x32x16_bf16 v[128:143], a[160:163], v[64:67], v[128:143]
    ds_read_b128 v[80:83], v98 offset:49152
    s_waitcnt lgkmcnt(3)
    v_mfma_f32_32x32x16_bf16 v[144:159], a[160:163], v[68:71], v[144:159]
    ds_read_b128 v[84:87], v98 offset:53248
    v_mfma_f32_32x32x16_bf16 v[160:175], a[164:167], v[64:67], v[160:175]
    ds_read_b128 v[88:91], v99 offset:49152
    v_mfma_f32_32x32x16_bf16 v[176:191], a[164:167], v[68:71], v[176:191]
    ds_read_b128 v[92:95], v99 offset:53248
    s_waitcnt lgkmcnt(5)
    v_mfma_f32_32x32x16_bf16 v[128:143], a[168:171], v[72:75], v[128:143]
    s_waitcnt lgkmcnt(4)
    v_mfma_f32_32x32x16_bf16 v[144:159], a[168:171], v[76:79], v[144:159]
    v_mfma_f32_32x32x16_bf16 v[160:175], a[172:175], v[72:75], v[160:175]
    v_mfma_f32_32x32x16_bf16 v[176:191], a[172:175], v[76:79], v[176:191]
    s_waitcnt lgkmcnt(3)
    v_mfma_f32_32x32x16_bf16 v[128:143], a[176:179], v[80:83], v[128:143]
    s_add_u32 m0, s53, 20480
    s_add_u32 s60, s48, 33152
    buffer_load_dwordx4 v2, s[24:27], s60 offen nt lds
    ds_read_b128 v[64:67], v100 offset:24576
    s_waitcnt lgkmcnt(3)
    v_mfma_f32_32x32x16_bf16 v[144:159], a[176:179], v[84:87], v[144:159]
    ds_read_b128 v[68:71], v100 offset:28672
    v_mfma_f32_32x32x16_bf16 v[160:175], a[180:183], v[80:83], v[160:175]
    ds_read_b128 v[72:75], v101 offset:24576
    v_mfma_f32_32x32x16_bf16 v[176:191], a[180:183], v[84:87], v[176:191]
    buffer_load_dwordx4 v3, s[24:27], s60 offen offset:1024 nt lds
    ds_read_b128 v[76:79], v101 offset:28672
    s_waitcnt lgkmcnt(5)
    v_mfma_f32_32x32x16_bf16 v[128:143], a[184:187], v[88:91], v[128:143]
    s_waitcnt lgkmcnt(4)
    v_mfma_f32_32x32x16_bf16 v[144:159], a[184:187], v[92:95], v[144:159]
    v_mfma_f32_32x32x16_bf16 v[160:175], a[188:191], v[88:91], v[160:175]
    buffer_load_dwordx4 v4, s[24:27], s60 offen offset:2048 nt lds
    v_mfma_f32_32x32x16_bf16 v[176:191], a[188:191], v[92:95], v[176:191]
    s_waitcnt lgkmcnt(3)
    v_mfma_f32_32x32x16_bf16 v[128:143], a[192:195], v[64:67], v[128:143]
    ds_read_b128 v[80:83], v102 offset:24576
    s_waitcnt lgkmcnt(3)
    v_mfma_f32_32x32x16_bf16 v[144:159], a[192:195], v[68:71], v[144:159]
    buffer_load_dwordx4 v5, s[24:27], s60 offen offset:3072 nt lds
    ds_read_b128 v[84:87], v102 offset:28672
    v_mfma_f32_32x32x16_bf16 v[160:175], a[196:199], v[64:67], v[160:175]
    ds_read_b128 v[88:91], v103 offset:24576
    v_mfma_f32_32x32x16_bf16 v[176:191], a[196:199], v[68:71], v[176:191]
    ds_read_b128 v[92:95], v103 offset:28672
    s_waitcnt lgkmcnt(5)
    v_mfma_f32_32x32x16_bf16 v[128:143], a[200:203], v[72:75], v[128:143]
    s_add_u32 m0, s53, 24576
    s_add_u32 s60, s49, 49152
    buffer_load_dwordx4 v2, s[24:27], s60 offen nt lds
    s_waitcnt lgkmcnt(4)
    v_mfma_f32_32x32x16_bf16 v[144:159], a[200:203], v[76:79], v[144:159]
    v_mfma_f32_32x32x16_bf16 v[160:175], a[204:207], v[72:75], v[160:175]
    v_mfma_f32_32x32x16_bf16 v[176:191], a[204:207], v[76:79], v[176:191]
    buffer_load_dwordx4 v3, s[24:27], s60 offen offset:1024 nt lds
    s_waitcnt lgkmcnt(3)
    v_mfma_f32_32x32x16_bf16 v[128:143], a[208:211], v[80:83], v[128:143]
    s_waitcnt lgkmcnt(2)
    v_mfma_f32_32x32x16_bf16 v[144:159], a[208:211], v[84:87], v[144:159]
    v_mfma_f32_32x32x16_bf16 v[160:175], a[212:215], v[80:83], v[160:175]
    v_mfma_f32_32x32x16_bf16 v[176:191], a[212:215], v[84:87], v[176:191]
    buffer_load_dwordx4 v4, s[24:27], s60 offen offset:2048 nt lds
    s_waitcnt lgkmcnt(1)
    v_mfma_f32_32x32x16_bf16 v[128:143], a[216:219], v[88:91], v[128:143]
    s_waitcnt lgkmcnt(0)
    v_mfma_f32_32x32x16_bf16 v[144:159], a[216:219], v[92:95], v[144:159]
    v_mfma_f32_32x32x16_bf16 v[160:175], a[220:223], v[88:91], v[160:175]
    buffer_load_dwordx4 v5, s[24:27], s60 offen offset:3072 nt lds
    v_mfma_f32_32x32x16_bf16 v[176:191], a[220:223], v[92:95], v[176:191]
    s_nop 6
    v_cvt_pk_bf16_f32 v32, v128, v129
    v_cvt_pk_bf16_f32 v33, v130, v131
    v_cvt_pk_bf16_f32 v34, v132, v133
    v_cvt_pk_bf16_f32 v35, v134, v135
    ds_write_b128 v27, v[32:35] offset:0
    v_cvt_pk_bf16_f32 v40, v136, v137
    v_cvt_pk_bf16_f32 v41, v138, v139
    v_cvt_pk_bf16_f32 v42, v140, v141
    s_add_u32 m0, s53, 28672
    s_add_u32 s60, s49, 49280
    buffer_load_dwordx4 v2, s[24:27], s60 offen nt lds
    v_cvt_pk_bf16_f32 v43, v142, v143
    ds_write_b128 v27, v[40:43] offset:2048
    v_cvt_pk_bf16_f32 v36, v144, v145
    v_cvt_pk_bf16_f32 v37, v146, v147
    v_cvt_pk_bf16_f32 v38, v148, v149
    v_cvt_pk_bf16_f32 v39, v150, v151
    ds_write_b128 v27, v[36:39] offset:1024
    v_cvt_pk_bf16_f32 v44, v152, v153
    v_cvt_pk_bf16_f32 v45, v154, v155
    v_cvt_pk_bf16_f32 v46, v156, v157
    v_cvt_pk_bf16_f32 v47, v158, v159
    ds_write_b128 v27, v[44:47] offset:3072
    buffer_load_dwordx4 v3, s[24:27], s60 offen offset:1024 nt lds
    v_cvt_pk_bf16_f32 v48, v160, v161
    v_cvt_pk_bf16_f32 v49, v162, v163
    v_cvt_pk_bf16_f32 v50, v164, v165
    v_cvt_pk_bf16_f32 v51, v166, v167
    ds_write_b128 v27, v[48:51] offset:4096
    v_cvt_pk_bf16_f32 v56, v168, v169
    v_cvt_pk_bf16_f32 v57, v170, v171
    v_cvt_pk_bf16_f32 v58, v172, v173
    v_cvt_pk_bf16_f32 v59, v174, v175
    ds_write_b128 v27, v[56:59] offset:6144
    v_cvt_pk_bf16_f32 v52, v176, v177
    v_cvt_pk_bf16_f32 v53, v178, v179
    v_cvt_pk_bf16_f32 v54, v180, v181
    v_cvt_pk_bf16_f32 v55, v182, v183
    buffer_load_dwordx4 v4, s[24:27], s60 offen offset:2048 nt lds
    ds_write_b128 v27, v[52:55] offset:5120
    v_cvt_pk_bf16_f32 v60, v184, v185
    v_cvt_pk_bf16_f32 v61, v186, v187
    v_cvt_pk_bf16_f32 v62, v188, v189
    v_cvt_pk_bf16_f32 v63, v190, v191
    ds_write_b128 v27, v[60:63] offset:7168
    s_waitcnt lgkmcnt(0)
    s_barrier
    ds_read_b128 a[224:227], v28 offset:0
    buffer_load_dwordx4 v5, s[24:27], s60 offen offset:3072 nt lds
    ds_read_b128 a[228:231], v28 offset:1024
    ds_read_b128 a[232:235], v28 offset:2048
    ds_read_b128 a[236:239], v28 offset:3072
    ds_read_b128 a[240:243], v28 offset:4096
    ds_read_b128 a[244:247], v28 offset:5120
    ds_read_b128 a[248:251], v28 offset:6144
    ds_read_b128 a[252:255], v28 offset:7168
    ds_read_b128 a[128:131], v28 offset:40960
    ds_read_b128 a[132:135], v28 offset:41984
    s_waitcnt lgkmcnt(9)
    v_mfma_f32_32x32x16_bf16 v[128:143], a[0:3], a[224:227], 0
    ds_read_b128 a[136:139], v28 offset:43008
    ds_read_b128 a[140:143], v28 offset:44032
    s_waitcnt lgkmcnt(10)
    v_mfma_f32_32x32x16_bf16 v[144:159], a[0:3], a[228:231], 0
    s_add_u32 m0, s53, 8192
    s_add_u32 s60, s49, 49408
    buffer_load_dwordx4 v2, s[24:27], s60 offen nt lds
    ds_read_b128 a[144:147], v28 offset:45056
    ds_read_b128 a[148:151], v28 offset:46080
    s_waitcnt lgkmcnt(11)
    v_mfma_f32_32x32x16_bf16 v[128:143], a[4:7], a[232:235], v[128:143]
    ds_read_b128 a[152:155], v28 offset:47104
    ds_read_b128 a[156:159], v28 offset:48128
    s_waitcnt lgkmcnt(12)
    v_mfma_f32_32x32x16_bf16 v[144:159], a[4:7], a[236:239], v[144:159]
    ds_read_b128 a[160:163], v29 offset:16384
    ds_read_b128 a[164:167], v29 offset:17408
    s_waitcnt lgkmcnt(13)
    v_mfma_f32_32x32x16_bf16 v[128:143], a[8:11], a[240:243], v[128:143]
    buffer_load_dwordx4 v3, s[24:27], s60 offen offset:1024 nt lds
    ds_read_b128 a[168:171], v29 offset:18432
    ds_read_b128 a[172:175], v29 offset:19456
    s_waitcnt lgkmcnt(14)
    v_mfma_f32_32x32x16_bf16 v[144:159], a[8:11], a[244:247], v[144:159]
    ds_read_b128 a[176:179], v29 offset:20480
    ds_read_b128 a[180:183], v29 offset:21504
    s_waitcnt lgkmcnt(14)
    v_mfma_f32_32x32x16_bf16 v[128:143], a[12:15], a[248:251], v[128:143]
    ds_read_b128 a[184:187], v29 offset:22528
    ds_read_b128 a[188:191], v29 offset:23552
    v_mfma_f32_32x32x16_bf16 v[144:159], a[12:15], a[252:255], v[144:159]
    buffer_load_dwordx4 v4, s[24:27], s60 offen offset:2048 nt lds
    ds_read_b128 a[192:195], v29 offset:57344
    ds_read_b128 a[196:199], v29 offset:58368
    s_waitcnt lgkmcnt(14)
    v_mfma_f32_32x32x16_bf16 v[128:143], a[16:19], a[128:131], v[128:143]
    s_waitcnt vmcnt(23)
    ds_read_b128 a[0:3], v19 offset:32768
    ds_read_b128 a[4:7], v20 offset:32768
    ds_read_b128 a[200:203], v29 offset:59392
    ds_read_b128 a[204:207], v29 offset:60416
    v_mfma_f32_32x32x16_bf16 v[144:159], a[16:19], a[132:135], v[144:159]
    ds_read_b128 a[8:11], v21 offset:32768
    ds_read_b128 a[12:15], v22 offset:32768
    ds_read_b128 a[208:211], v29 offset:61440
    ds_read_b128 a[212:215], v29 offset:62464
    v_mfma_f32_32x32x16_bf16 v[128:143], a[20:23], a[136:139], v[128:143]
    buffer_load_dwordx4 v5, s[24:27], s60 offen offset:3072 nt lds
    ds_read_b128 a[216:219], v29 offset:63488
    ds_read_b128 a[220:223], v29 offset:64512
    v_mfma_f32_32x32x16_bf16 v[144:159], a[20:23], a[140:143], v[144:159]
    s_waitcnt lgkmcnt(14)
    v_mfma_f32_32x32x16_bf16 v[128:143], a[24:27], a[144:147], v[128:143]
    v_mfma_f32_32x32x16_bf16 v[144:159], a[24:27], a[148:151], v[144:159]
    s_add_u32 m0, s53, 12288
    s_add_u32 s60, s49, 49536
    buffer_load_dwordx4 v2, s[24:27], s60 offen nt lds
    v_mfma_f32_32x32x16_bf16 v[128:143], a[28:31], a[152:155], v[128:143]
    v_mfma_f32_32x32x16_bf16 v[144:159], a[28:31], a[156:159], v[144:159]
    s_waitcnt lgkmcnt(4)
    v_mfma_f32_32x32x16_bf16 v[128:143], a[32:35], a[160:163], v[128:143]
    buffer_load_dwordx4 v3, s[24:27], s60 offen offset:1024 nt lds
    s_waitcnt vmcnt(22)
    ds_read_b128 a[16:19], v19 offset:36864
    ds_read_b128 a[20:23], v20 offset:36864
    v_mfma_f32_32x32x16_bf16 v[144:159], a[32:35], a[164:167], v[144:159]
    ds_read_b128 a[24:27], v21 offset:36864
    ds_read_b128 a[28:31], v22 offset:36864
    v_mfma_f32_32x32x16_bf16 v[128:143], a[36:39], a[168:171], v[128:143]
    v_mfma_f32_32x32x16_bf16 v[144:159], a[36:39], a[172:175], v[144:159]
    buffer_load_dwordx4 v4, s[24:27], s60 offen offset:2048 nt lds
    v_mfma_f32_32x32x16_bf16 v[128:143], a[40:43], a[176:179], v[128:143]
    v_mfma_f32_32x32x16_bf16 v[144:159], a[40:43], a[180:183], v[144:159]
    v_mfma_f32_32x32x16_bf16 v[128:143], a[44:47], a[184:187], v[128:143]
    buffer_load_dwordx4 v5, s[24:27], s60 offen offset:3072 nt lds
    v_mfma_f32_32x32x16_bf16 v[144:159], a[44:47], a[188:191], v[144:159]
    s_waitcnt lgkmcnt(0)
    v_mfma_f32_32x32x16_bf16 v[128:143], a[48:51], a[192:195], v[128:143]
    s_waitcnt vmcnt(20)
    ds_read_b128 a[32:35], v19 offset:16384
    ds_read_b128 a[36:39], v20 offset:16384
    v_mfma_f32_32x32x16_bf16 v[144:159], a[48:51], a[196:199], v[144:159]
    ds_read_b128 a[40:43], v21 offset:16384
    ds_read_b128 a[44:47], v22 offset:16384
    v_mfma_f32_32x32x16_bf16 v[128:143], a[52:55], a[200:203], v[128:143]
    v_mfma_f32_32x32x16_bf16 v[144:159], a[52:55], a[204:207], v[144:159]
    v_mfma_f32_32x32x16_bf16 v[128:143], a[56:59], a[208:211], v[128:143]
    v_mfma_f32_32x32x16_bf16 v[144:159], a[56:59], a[212:215], v[144:159]
    v_mfma_f32_32x32x16_bf16 v[128:143], a[60:63], a[216:219], v[128:143]
    v_mfma_f32_32x32x16_bf16 v[144:159], a[60:63], a[220:223], v[144:159]
    s_waitcnt lgkmcnt(0)
    v_mfma_f32_32x32x16_bf16 v[160:175], a[64:67], a[224:227], 0
    s_waitcnt vmcnt(16)
    ds_read_b128 a[48:51], v19 offset:20480
    ds_read_b128 a[52:55], v20 offset:20480
    v_mfma_f32_32x32x16_bf16 v[176:191], a[64:67], a[228:231], 0
    ds_read_b128 a[56:59], v21 offset:20480
    ds_read_b128 a[60:63], v22 offset:20480
    v_mfma_f32_32x32x16_bf16 v[160:175], a[68:71], a[232:235], v[160:175]
    s_nop 1
    v_max3_f32 v112, v128, v129, v130
    v_max_f32 v112, v112, v143
    v_max3_f32 v112, v112, v131, v132
    v_mfma_f32_32x32x16_bf16 v[176:191], a[68:71], a[236:239], v[176:191]
    v_max3_f32 v112, v112, v133, v134
    v_max3_f32 v112, v112, v135, v136
    v_max3_f32 v112, v112, v137, v138
    v_mfma_f32_32x32x16_bf16 v[160:175], a[72:75], a[240:243], v[160:175]
    v_max3_f32 v112, v112, v139, v140
    v_max3_f32 v112, v112, v141, v142
    v_max3_f32 v113, v144, v145, v146
    v_mfma_f32_32x32x16_bf16 v[176:191], a[72:75], a[244:247], v[176:191]
    v_max_f32 v113, v113, v159
    v_max3_f32 v113, v113, v147, v148
    v_max3_f32 v113, v113, v149, v150
    v_mfma_f32_32x32x16_bf16 v[160:175], a[76:79], a[248:251], v[160:175]
    v_max3_f32 v113, v113, v151, v152
    v_max3_f32 v113, v113, v153, v154
    v_max3_f32 v113, v113, v155, v156
    v_mfma_f32_32x32x16_bf16 v[176:191], a[76:79], a[252:255], v[176:191]
    s_waitcnt lgkmcnt(0)
    s_add_u32 m0, s53, 32768
    s_add_u32 s60, s50, 0
    buffer_load_dwordx4 v6, s[28:31], s60 offen nt lds
    v_max3_f32 v113, v113, v157, v158
    v_mfma_f32_32x32x16_bf16 v[160:175], a[80:83], a[128:131], v[160:175]
    buffer_load_dwordx4 v7, s[28:31], s60 offen offset:1024 nt lds
    s_waitcnt vmcnt(14)
    ds_read_b128 a[64:67], v19 offset:24576
    ds_read_b128 a[68:71], v20 offset:24576
    v_mfma_f32_32x32x16_bf16 v[176:191], a[80:83], a[132:135], v[176:191]
    buffer_load_dwordx4 v8, s[28:31], s60 offen offset:2048 nt lds
    ds_read_b128 a[72:75], v21 offset:24576
    ds_read_b128 a[76:79], v22 offset:24576
    v_mfma_f32_32x32x16_bf16 v[160:175], a[84:87], a[136:139], v[160:175]
    buffer_load_dwordx4 v9, s[28:31], s60 offen offset:3072 nt lds
    v_mfma_f32_32x32x16_bf16 v[176:191], a[84:87], a[140:143], v[176:191]
    v_mfma_f32_32x32x16_bf16 v[160:175], a[88:91], a[144:147], v[160:175]
    v_mfma_f32_32x32x16_bf16 v[176:191], a[88:91], a[148:151], v[176:191]
    v_mfma_f32_32x32x16_bf16 v[160:175], a[92:95], a[152:155], v[160:175]
    v_mfma_f32_32x32x16_bf16 v[176:191], a[92:95], a[156:159], v[176:191]
    s_waitcnt lgkmcnt(0)
    s_add_u32 m0, s53, 36864
    s_add_u32 s60, s50, 65536
    buffer_load_dwordx4 v6, s[28:31], s60 offen nt lds
    v_mfma_f32_32x32x16_bf16 v[160:175], a[96:99], a[160:163], v[160:175]
    buffer_load_dwordx4 v7, s[28:31], s60 offen offset:1024 nt lds
    s_waitcnt vmcnt(14)
    ds_read_b128 a[80:83], v19 offset:28672
    ds_read_b128 a[84:87], v20 offset:28672
    v_mfma_f32_32x32x16_bf16 v[176:191], a[96:99], a[164:167], v[176:191]
    buffer_load_dwordx4 v8, s[28:31], s60 offen offset:2048 nt lds
    ds_read_b128 a[88:91], v21 offset:28672
    ds_read_b128 a[92:95], v22 offset:28672
    v_mfma_f32_32x32x16_bf16 v[160:175], a[100:103], a[168:171], v[160:175]
    v_mfma_f32_32x32x16_bf16 v[176:191], a[100:103], a[172:175], v[176:191]
    v_mfma_f32_32x32x16_bf16 v[160:175], a[104:107], a[176:179], v[160:175]
    buffer_load_dwordx4 v9, s[28:31], s60 offen offset:3072 nt lds
    v_mfma_f32_32x32x16_bf16 v[176:191], a[104:107], a[180:183], v[176:191]
    v_mfma_f32_32x32x16_bf16 v[160:175], a[108:111], a[184:187], v[160:175]
    v_mfma_f32_32x32x16_bf16 v[176:191], a[108:111], a[188:191], v[176:191]
    s_waitcnt lgkmcnt(0)
    v_mfma_f32_32x32x16_bf16 v[160:175], a[112:115], a[192:195], v[160:175]
    s_waitcnt vmcnt(12)
    ds_read_b128 a[96:99], v19 offset:8192
    ds_read_b128 a[100:103], v20 offset:8192
    v_mfma_f32_32x32x16_bf16 v[176:191], a[112:115], a[196:199], v[176:191]
    s_add_u32 m0, s53, 16384
    s_add_u32 s60, s50, 131072
    buffer_load_dwordx4 v6, s[28:31], s60 offen nt lds
    ds_read_b128 a[104:107], v21 offset:8192
    ds_read_b128 a[108:111], v22 offset:8192
    v_mfma_f32_32x32x16_bf16 v[160:175], a[116:119], a[200:203], v[160:175]
    v_mfma_f32_32x32x16_bf16 v[176:191], a[116:119], a[204:207], v[176:191]
    v_mfma_f32_32x32x16_bf16 v[160:175], a[120:123], a[208:211], v[160:175]
    v_mfma_f32_32x32x16_bf16 v[176:191], a[120:123], a[212:215], v[176:191]
    buffer_load_dwordx4 v7, s[28:31], s60 offen offset:1024 nt lds
    v_mfma_f32_32x32x16_bf16 v[160:175], a[124:127], a[216:219], v[160:175]
    v_mfma_f32_32x32x16_bf16 v[176:191], a[124:127], a[220:223], v[176:191]
    s_waitcnt lgkmcnt(0)
    v_mfma_f32_32x32x16_bf16 v[192:207], a[0:3], a[224:227], 0
    v_mfma_f32_32x32x16_bf16 v[208:223], a[0:3], a[228:231], 0
    buffer_load_dwordx4 v8, s[28:31], s60 offen offset:2048 nt lds
    v_mfma_f32_32x32x16_bf16 v[192:207], a[4:7], a[232:235], v[192:207]
    s_nop 5
    v_max3_f32 v112, v112, v160, v161
    v_max3_f32 v112, v112, v162, v163
    v_max3_f32 v112, v112, v164, v165
    v_mfma_f32_32x32x16_bf16 v[208:223], a[4:7], a[236:239], v[208:223]
    v_max3_f32 v112, v112, v166, v167
    v_max3_f32 v112, v112, v168, v169
    v_max3_f32 v112, v112, v170, v171
    v_mfma_f32_32x32x16_bf16 v[192:207], a[8:11], a[240:243], v[192:207]
    v_max3_f32 v112, v112, v172, v173
    v_max3_f32 v112, v112, v174, v175
    v_max3_f32 v113, v113, v176, v177
    v_mfma_f32_32x32x16_bf16 v[208:223], a[8:11], a[244:247], v[208:223]
    v_max3_f32 v113, v113, v178, v179
    v_max3_f32 v113, v113, v180, v181
    v_max3_f32 v113, v113, v182, v183
    v_mfma_f32_32x32x16_bf16 v[192:207], a[12:15], a[248:251], v[192:207]
    buffer_load_dwordx4 v9, s[28:31], s60 offen offset:3072 nt lds
    s_waitcnt vmcnt(12)
    ds_read_b128 a[112:115], v19 offset:12288
    ds_read_b128 a[116:119], v20 offset:12288
    v_max3_f32 v113, v113, v184, v185
    v_max3_f32 v113, v113, v186, v187
    v_max3_f32 v113, v113, v188, v189
    v_mfma_f32_32x32x16_bf16 v[208:223], a[12:15], a[252:255], v[208:223]
    ds_read_b128 a[120:123], v21 offset:12288
    ds_read_b128 a[124:127], v22 offset:12288
    v_max3_f32 v113, v113, v190, v191
    v_mfma_f32_32x32x16_bf16 v[192:207], a[16:19], a[128:131], v[192:207]
    v_mfma_f32_32x32x16_bf16 v[208:223], a[16:19], a[132:135], v[208:223]
    v_mfma_f32_32x32x16_bf16 v[192:207], a[20:23], a[136:139], v[192:207]
    s_add_u32 m0, s53, 20480
    s_add_u32 s60, s50, 196608
    buffer_load_dwordx4 v6, s[28:31], s60 offen nt lds
    v_mfma_f32_32x32x16_bf16 v[208:223], a[20:23], a[140:143], v[208:223]
    v_mfma_f32_32x32x16_bf16 v[192:207], a[24:27], a[144:147], v[192:207]
    v_mfma_f32_32x32x16_bf16 v[208:223], a[24:27], a[148:151], v[208:223]
    s_waitcnt lgkmcnt(0)
    v_mfma_f32_32x32x16_bf16 v[192:207], a[28:31], a[152:155], v[192:207]
    buffer_load_dwordx4 v7, s[28:31], s60 offen offset:1024 nt lds
    v_mfma_f32_32x32x16_bf16 v[208:223], a[28:31], a[156:159], v[208:223]
    v_mfma_f32_32x32x16_bf16 v[192:207], a[32:35], a[160:163], v[192:207]
    v_mfma_f32_32x32x16_bf16 v[208:223], a[32:35], a[164:167], v[208:223]
    v_mfma_f32_32x32x16_bf16 v[192:207], a[36:39], a[168:171], v[192:207]
    v_mfma_f32_32x32x16_bf16 v[208:223], a[36:39], a[172:175], v[208:223]
    buffer_load_dwordx4 v8, s[28:31], s60 offen offset:2048 nt lds
    v_mfma_f32_32x32x16_bf16 v[192:207], a[40:43], a[176:179], v[192:207]
    v_mfma_f32_32x32x16_bf16 v[208:223], a[40:43], a[180:183], v[208:223]
    v_mfma_f32_32x32x16_bf16 v[192:207], a[44:47], a[184:187], v[192:207]
    v_mfma_f32_32x32x16_bf16 v[208:223], a[44:47], a[188:191], v[208:223]
    buffer_load_dwordx4 v9, s[28:31], s60 offen offset:3072 nt lds
    s_waitcnt vmcnt(12)
    ds_read_b64_tr_b16 a[0:1], v25 offset:32768
    ds_read_b64_tr_b16 a[2:3], v25 offset:33792
    v_mfma_f32_32x32x16_bf16 v[192:207], a[48:51], a[192:195], v[192:207]
    ds_read_b64_tr_b16 a[4:5], v26 offset:32768
    ds_read_b64_tr_b16 a[6:7], v26 offset:33792
    v_mfma_f32_32x32x16_bf16 v[208:223], a[48:51], a[196:199], v[208:223]
    ds_read_b64_tr_b16 a[8:9], v25 offset:34816
    ds_read_b64_tr_b16 a[10:11], v25 offset:35840
    v_mfma_f32_32x32x16_bf16 v[192:207], a[52:55], a[200:203], v[192:207]
    ds_read_b64_tr_b16 a[12:13], v26 offset:34816
    ds_read_b64_tr_b16 a[14:15], v26 offset:35840
    v_mfma_f32_32x32x16_bf16 v[208:223], a[52:55], a[204:207], v[208:223]
    s_add_u32 m0, s53, 24576
    s_add_u32 s60, s51, 16384
    buffer_load_dwordx4 v6, s[28:31], s60 offen nt lds
    v_mfma_f32_32x32x16_bf16 v[192:207], a[56:59], a[208:211], v[192:207]
    v_mfma_f32_32x32x16_bf16 v[208:223], a[56:59], a[212:215], v[208:223]
    v_mfma_f32_32x32x16_bf16 v[192:207], a[60:63], a[216:219], v[192:207]
    v_mfma_f32_32x32x16_bf16 v[208:223], a[60:63], a[220:223], v[208:223]
    v_mfma_f32_32x32x16_bf16 v[224:239], a[64:67], a[224:227], 0
    s_waitcnt lgkmcnt(0)
    buffer_load_dwordx4 v7, s[28:31], s60 offen offset:1024 nt lds
    v_mfma_f32_32x32x16_bf16 v[240:255], a[64:67], a[228:231], 0
    v_mfma_f32_32x32x16_bf16 v[224:239], a[68:71], a[232:235], v[224:239]
    s_nop 5
    v_max3_f32 v112, v112, v192, v193
    v_max3_f32 v112, v112, v194, v195
    v_max3_f32 v112, v112, v196, v197
    v_mfma_f32_32x32x16_bf16 v[240:255], a[68:71], a[236:239], v[240:255]
    v_max3_f32 v112, v112, v198, v199
    v_max3_f32 v112, v112, v200, v201
    v_max3_f32 v112, v112, v202, v203
    v_mfma_f32_32x32x16_bf16 v[224:239], a[72:75], a[240:243], v[224:239]
    buffer_load_dwordx4 v8, s[28:31], s60 offen offset:2048 nt lds
    v_max3_f32 v112, v112, v204, v205
    v_max3_f32 v112, v112, v206, v207
    v_max3_f32 v113, v113, v208, v209
    v_mfma_f32_32x32x16_bf16 v[240:255], a[72:75], a[244:247], v[240:255]
    v_max3_f32 v113, v113, v210, v211
    v_max3_f32 v113, v113, v212, v213
    v_max3_f32 v113, v113, v214, v215
    v_mfma_f32_32x32x16_bf16 v[224:239], a[76:79], a[248:251], v[224:239]
    v_max3_f32 v113, v113, v216, v217
    v_max3_f32 v113, v113, v218, v219
    v_max3_f32 v113, v113, v220, v221
    v_mfma_f32_32x32x16_bf16 v[240:255], a[76:79], a[252:255], v[240:255]
    v_max3_f32 v113, v113, v222, v223
    v_mfma_f32_32x32x16_bf16 v[224:239], a[80:83], a[128:131], v[224:239]
    v_mfma_f32_32x32x16_bf16 v[240:255], a[80:83], a[132:135], v[240:255]
    buffer_load_dwordx4 v9, s[28:31], s60 offen offset:3072 nt lds
    s_waitcnt vmcnt(12)
    ds_read_b64_tr_b16 a[16:17], v25 offset:36864
    ds_read_b64_tr_b16 a[18:19], v25 offset:37888
    v_mfma_f32_32x32x16_bf16 v[224:239], a[84:87], a[136:139], v[224:239]
    ds_read_b64_tr_b16 a[20:21], v26 offset:36864
    ds_read_b64_tr_b16 a[22:23], v26 offset:37888
    v_mfma_f32_32x32x16_bf16 v[240:255], a[84:87], a[140:143], v[240:255]
    ds_read_b64_tr_b16 a[24:25], v25 offset:38912
    ds_read_b64_tr_b16 a[26:27], v25 offset:39936
    v_mfma_f32_32x32x16_bf16 v[224:239], a[88:91], a[144:147], v[224:239]
    ds_read_b64_tr_b16 a[28:29], v26 offset:38912
    ds_read_b64_tr_b16 a[30:31], v26 offset:39936
    v_mfma_f32_32x32x16_bf16 v[240:255], a[88:91], a[148:151], v[240:255]
    s_add_u32 m0, s53, 28672
    s_add_u32 s60, s51, 81920
    buffer_load_dwordx4 v6, s[28:31], s60 offen nt lds
    v_mfma_f32_32x32x16_bf16 v[224:239], a[92:95], a[152:155], v[224:239]
    v_mfma_f32_32x32x16_bf16 v[240:255], a[92:95], a[156:159], v[240:255]
    v_mfma_f32_32x32x16_bf16 v[224:239], a[96:99], a[160:163], v[224:239]
    v_mfma_f32_32x32x16_bf16 v[240:255], a[96:99], a[164:167], v[240:255]
    buffer_load_dwordx4 v7, s[28:31], s60 offen offset:1024 nt lds
    v_mfma_f32_32x32x16_bf16 v[224:239], a[100:103], a[168:171], v[224:239]
    s_waitcnt lgkmcnt(0)
    v_mfma_f32_32x32x16_bf16 v[240:255], a[100:103], a[172:175], v[240:255]
    v_mfma_f32_32x32x16_bf16 v[224:239], a[104:107], a[176:179], v[224:239]
    v_mfma_f32_32x32x16_bf16 v[240:255], a[104:107], a[180:183], v[240:255]
    v_mfma_f32_32x32x16_bf16 v[224:239], a[108:111], a[184:187], v[224:239]
    buffer_load_dwordx4 v8, s[28:31], s60 offen offset:2048 nt lds
    v_mfma_f32_32x32x16_bf16 v[240:255], a[108:111], a[188:191], v[240:255]
    v_mfma_f32_32x32x16_bf16 v[224:239], a[112:115], a[192:195], v[224:239]
    v_mfma_f32_32x32x16_bf16 v[240:255], a[112:115], a[196:199], v[240:255]
    v_mfma_f32_32x32x16_bf16 v[224:239], a[116:119], a[200:203], v[224:239]
    buffer_load_dwordx4 v9, s[28:31], s60 offen offset:3072 nt lds
    s_waitcnt vmcnt(12)
    ds_read_b64_tr_b16 a[32:33], v25 offset:16384
    ds_read_b64_tr_b16 a[34:35], v25 offset:17408
    v_mfma_f32_32x32x16_bf16 v[240:255], a[116:119], a[204:207], v[240:255]
    ds_read_b64_tr_b16 a[36:37], v26 offset:16384
    ds_read_b64_tr_b16 a[38:39], v26 offset:17408
    v_mfma_f32_32x32x16_bf16 v[224:239], a[120:123], a[208:211], v[224:239]
    ds_read_b64_tr_b16 a[40:41], v25 offset:18432
    ds_read_b64_tr_b16 a[42:43], v25 offset:19456
    v_mfma_f32_32x32x16_bf16 v[240:255], a[120:123], a[212:215], v[240:255]
    ds_read_b64_tr_b16 a[44:45], v26 offset:18432
    ds_read_b64_tr_b16 a[46:47], v26 offset:19456
    v_mfma_f32_32x32x16_bf16 v[224:239], a[124:127], a[216:219], v[224:239]
    s_add_u32 m0, s53, 8192
    s_add_u32 s60, s51, 147456
    buffer_load_dwordx4 v6, s[28:31], s60 offen nt lds
    v_mfma_f32_32x32x16_bf16 v[240:255], a[124:127], a[220:223], v[240:255]
    s_nop 7
    v_max3_f32 v112, v112, v224, v225
    v_max3_f32 v112, v112, v226, v227
    v_max3_f32 v112, v112, v228, v229
    v_max3_f32 v112, v112, v230, v231
    v_max3_f32 v112, v112, v232, v233
    v_max3_f32 v112, v112, v234, v235
    v_max3_f32 v112, v112, v236, v237
    v_max3_f32 v112, v112, v238, v239
    v_max3_f32 v113, v113, v240, v241
    v_max3_f32 v113, v113, v242, v243
    v_max3_f32 v113, v113, v244, v245
    v_max3_f32 v113, v113, v246, v247
    v_max3_f32 v113, v113, v248, v249
    v_max3_f32 v113, v113, v250, v251
    v_max3_f32 v113, v113, v252, v253
    v_max3_f32 v113, v113, v254, v255
    s_nop 1
    v_permlane32_swap_b32 v112, v113
    v_max_f32 v112, v112, v113
    ds_write_b32 v31, v112 offset:36864
    v_and_b32 v108, 31, v0
    s_waitcnt lgkmcnt(1)
    buffer_load_dwordx4 v7, s[28:31], s60 offen offset:1024 nt lds
    v_lshlrev_b32 v108, 2, v108
    v_add_u32 v111, 122880, v108
    v_add_u32 v110, 81920, v108
    v_add_u32 v109, 40960, v108
    s_waitcnt lgkmcnt(0)
    s_barrier
    ds_read_b32 v96, v108 offset:36864
    ds_read_b32 v97, v108 offset:36992
    ds_read_b32 v98, v109 offset:36864
    ds_read_b32 v99, v109 offset:36992
    ds_read_b32 v100, v110 offset:36864
    ds_read_b32 v101, v110 offset:36992
    ds_read_b32 v102, v111 offset:36864
    ds_read_b32 v103, v111 offset:36992
    s_waitcnt lgkmcnt(3)
    v_max3_f32 v114, v96, v98, v100
    buffer_load_dwordx4 v8, s[28:31], s60 offen offset:2048 nt lds
    s_waitcnt lgkmcnt(1)
    v_max_f32 v114, v114, v102
    v_mul_f32 v114, s58, v114
    v_sub_f32 v114, 0, v114
    v_max3_f32 v115, v97, v99, v101
    s_waitcnt lgkmcnt(0)
    v_max_f32 v115, v115, v103
    v_mul_f32 v115, s58, v115
    v_sub_f32 v115, 0, v115
    v_fma_f32 v128, v128, s58, v114
    v_fma_f32 v129, v129, s58, v114
    v_fma_f32 v130, v130, s58, v114
    v_fma_f32 v131, v131, s58, v114
    v_fma_f32 v132, v132, s58, v114
    v_fma_f32 v133, v133, s58, v114
    v_fma_f32 v134, v134, s58, v114
    v_fma_f32 v135, v135, s58, v114
    v_exp_f32 v128, v128
    v_exp_f32 v129, v129
    v_exp_f32 v130, v130
    v_exp_f32 v131, v131
    v_exp_f32 v132, v132
    v_exp_f32 v133, v133
    buffer_load_dwordx4 v9, s[28:31], s60 offen offset:3072 nt lds
    s_waitcnt vmcnt(12)
    ds_read_b64_tr_b16 a[48:49], v25 offset:20480
    v_exp_f32 v134, v134
    ds_read_b64_tr_b16 a[50:51], v25 offset:21504
    v_exp_f32 v135, v135
    ds_read_b64_tr_b16 a[52:53], v26 offset:20480
    v_mov_b32 v104, v128
    ds_read_b64_tr_b16 a[54:55], v26 offset:21504
    v_mov_b32 v105, v129
    ds_read_b64_tr_b16 a[56:57], v25 offset:22528
    v_cvt_pk_bf16_f32 v128, v128, v129
    ds_read_b64_tr_b16 a[58:59], v25 offset:23552
    v_add_f32 v104, v104, v130
    ds_read_b64_tr_b16 a[60:61], v26 offset:22528
    v_add_f32 v105, v105, v131
    ds_read_b64_tr_b16 a[62:63], v26 offset:23552
    v_cvt_pk_bf16_f32 v129, v130, v131
    v_add_f32 v104, v104, v132
    v_add_f32 v105, v105, v133
    v_cvt_pk_bf16_f32 v130, v132, v133
    v_add_f32 v104, v104, v134
    v_add_f32 v105, v105, v135
    v_cvt_pk_bf16_f32 v131, v134, v135
    ds_write_b128 v27, v[128:131] offset:12288
    v_fma_f32 v144, v144, s58, v115
    s_add_u32 m0, s53, 16384
    s_add_u32 s60, s51, 212992
    buffer_load_dwordx4 v6, s[28:31], s60 offen nt lds
    v_fma_f32 v145, v145, s58, v115
    v_fma_f32 v146, v146, s58, v115
    v_fma_f32 v147, v147, s58, v115
    v_fma_f32 v148, v148, s58, v115
    v_fma_f32 v149, v149, s58, v115
    v_fma_f32 v150, v150, s58, v115
    v_fma_f32 v151, v151, s58, v115
    v_exp_f32 v144, v144
    v_exp_f32 v145, v145
    v_exp_f32 v146, v146
    v_exp_f32 v147, v147
    v_exp_f32 v148, v148
    v_exp_f32 v149, v149
    v_exp_f32 v150, v150
    s_waitcnt lgkmcnt(1)
    v_exp_f32 v151, v151
    v_mov_b32 v106, v144
    v_mov_b32 v107, v145
    v_cvt_pk_bf16_f32 v144, v144, v145
    v_add_f32 v106, v106, v146
    buffer_load_dwordx4 v7, s[28:31], s60 offen offset:1024 nt lds
    v_add_f32 v107, v107, v147
    v_cvt_pk_bf16_f32 v145, v146, v147
    v_add_f32 v106, v106, v148
    v_add_f32 v107, v107, v149
    v_cvt_pk_bf16_f32 v146, v148, v149
    v_add_f32 v106, v106, v150
    v_add_f32 v107, v107, v151
    v_cvt_pk_bf16_f32 v147, v150, v151
    ds_write_b128 v27, v[144:147] offset:13312
    v_fma_f32 v136, v136, s58, v114
    v_fma_f32 v137, v137, s58, v114
    v_fma_f32 v138, v138, s58, v114
    v_fma_f32 v139, v139, s58, v114
    v_fma_f32 v140, v140, s58, v114
    v_fma_f32 v141, v141, s58, v114
    v_fma_f32 v142, v142, s58, v114
    v_fma_f32 v143, v143, s58, v114
    v_exp_f32 v136, v136
    v_exp_f32 v137, v137
    v_exp_f32 v138, v138
    v_exp_f32 v139, v139
    v_exp_f32 v140, v140
    buffer_load_dwordx4 v8, s[28:31], s60 offen offset:2048 nt lds
    v_exp_f32 v141, v141
    v_exp_f32 v142, v142
    v_exp_f32 v143, v143
    v_add_f32 v104, v104, v136
    v_add_f32 v105, v105, v137
    v_cvt_pk_bf16_f32 v136, v136, v137
    v_add_f32 v104, v104, v138
    v_add_f32 v105, v105, v139
    v_cvt_pk_bf16_f32 v137, v138, v139
    v_add_f32 v104, v104, v140
    v_add_f32 v105, v105, v141
    v_cvt_pk_bf16_f32 v138, v140, v141
    v_add_f32 v104, v104, v142
    v_add_f32 v105, v105, v143
    v_cvt_pk_bf16_f32 v139, v142, v143
    ds_write_b128 v27, v[136:139] offset:14336
    v_fma_f32 v152, v152, s58, v115
    v_fma_f32 v153, v153, s58, v115
    v_fma_f32 v154, v154, s58, v115
    v_fma_f32 v155, v155, s58, v115
    v_fma_f32 v156, v156, s58, v115
    v_fma_f32 v157, v157, s58, v115
    buffer_load_dwordx4 v9, s[28:31], s60 offen offset:3072 nt lds
    s_waitcnt vmcnt(12)
    ds_read_b64_tr_b16 a[64:65], v25 offset:24576
    v_fma_f32 v158, v158, s58, v115
    ds_read_b64_tr_b16 a[66:67], v25 offset:25600
    v_fma_f32 v159, v159, s58, v115
    ds_read_b64_tr_b16 a[68:69], v26 offset:24576
    v_exp_f32 v152, v152
    ds_read_b64_tr_b16 a[70:71], v26 offset:25600
    v_exp_f32 v153, v153
    ds_read_b64_tr_b16 a[72:73], v25 offset:26624
    v_exp_f32 v154, v154
    ds_read_b64_tr_b16 a[74:75], v25 offset:27648
    v_exp_f32 v155, v155
    ds_read_b64_tr_b16 a[76:77], v26 offset:26624
    v_exp_f32 v156, v156
    ds_read_b64_tr_b16 a[78:79], v26 offset:27648
    v_exp_f32 v157, v157
    v_exp_f32 v158, v158
    v_exp_f32 v159, v159
    v_add_f32 v106, v106, v152
    v_add_f32 v107, v107, v153
    v_cvt_pk_bf16_f32 v152, v152, v153
    v_add_f32 v106, v106, v154
    s_add_u32 m0, s53, 20480
    s_add_u32 s60, s50, 32768
    buffer_load_dwordx4 v6, s[28:31], s60 offen nt lds
    v_add_f32 v107, v107, v155
    v_cvt_pk_bf16_f32 v153, v154, v155
    v_add_f32 v106, v106, v156
    v_add_f32 v107, v107, v157
    v_cvt_pk_bf16_f32 v154, v156, v157
    v_add_f32 v106, v106, v158
    v_add_f32 v107, v107, v159
    v_cvt_pk_bf16_f32 v155, v158, v159
    ds_write_b128 v27, v[152:155] offset:15360
    s_waitcnt lgkmcnt(0)
    s_barrier
    ds_read_b128 v[32:35], v28 offset:12288
    buffer_load_dwordx4 v7, s[28:31], s60 offen offset:1024 nt lds
    ds_read_b128 v[36:39], v28 offset:13312
    ds_read_b128 v[40:43], v28 offset:14336
    ds_read_b128 v[44:47], v28 offset:15360
    s_waitcnt lgkmcnt(3)
    v_mfma_f32_32x32x16_bf16 v[64:79], a[0:3], v[32:35], 0
    v_fma_f32 v160, v160, s58, v114
    v_fma_f32 v161, v161, s58, v114
    v_fma_f32 v162, v162, s58, v114
    v_fma_f32 v163, v163, s58, v114
    v_fma_f32 v164, v164, s58, v114
    ds_read_b128 v[48:51], v28 offset:53248
    s_waitcnt lgkmcnt(3)
    v_mfma_f32_32x32x16_bf16 v[80:95], a[0:3], v[36:39], 0
    v_fma_f32 v165, v165, s58, v114
    v_fma_f32 v166, v166, s58, v114
    v_fma_f32 v167, v167, s58, v114
    v_exp_f32 v160, v160
    v_exp_f32 v161, v161
    ds_read_b128 v[52:55], v28 offset:54272
    v_mfma_f32_32x32x16_bf16 v[128:143], a[4:7], v[32:35], 0
    v_exp_f32 v162, v162
    v_exp_f32 v163, v163
    v_exp_f32 v164, v164
    v_exp_f32 v165, v165
    v_exp_f32 v166, v166
    ds_read_b128 v[56:59], v28 offset:55296
    v_mfma_f32_32x32x16_bf16 v[144:159], a[4:7], v[36:39], 0
    buffer_load_dwordx4 v8, s[28:31], s60 offen offset:2048 nt lds
    v_exp_f32 v167, v167
    v_add_f32 v104, v104, v160
    v_add_f32 v105, v105, v161
    v_cvt_pk_bf16_f32 v160, v160, v161
    v_add_f32 v104, v104, v162
    ds_read_b128 v[60:63], v28 offset:56320
    s_waitcnt lgkmcnt(5)
    v_mfma_f32_32x32x16_bf16 v[64:79], a[8:11], v[40:43], v[64:79]
    v_add_f32 v105, v105, v163
    v_cvt_pk_bf16_f32 v161, v162, v163
    v_add_f32 v104, v104, v164
    v_add_f32 v105, v105, v165
    v_cvt_pk_bf16_f32 v162, v164, v165
    s_waitcnt lgkmcnt(4)
    v_mfma_f32_32x32x16_bf16 v[80:95], a[8:11], v[44:47], v[80:95]
    v_add_f32 v104, v104, v166
    v_add_f32 v105, v105, v167
    v_cvt_pk_bf16_f32 v163, v166, v167
    ds_write_b128 v27, v[160:163] offset:32768
    v_fma_f32 v176, v176, s58, v115
    v_mfma_f32_32x32x16_bf16 v[128:143], a[12:15], v[40:43], v[128:143]
    buffer_load_dwordx4 v9, s[28:31], s60 offen offset:3072 nt lds
    s_waitcnt vmcnt(12)
    ds_read_b64_tr_b16 a[80:81], v25 offset:28672
    ds_read_b64_tr_b16 a[82:83], v25 offset:29696
    v_fma_f32 v177, v177, s58, v115
    v_fma_f32 v178, v178, s58, v115
    v_fma_f32 v179, v179, s58, v115
    v_fma_f32 v180, v180, s58, v115
    v_fma_f32 v181, v181, s58, v115
    v_mfma_f32_32x32x16_bf16 v[144:159], a[12:15], v[44:47], v[144:159]
    ds_read_b64_tr_b16 a[84:85], v26 offset:28672
    ds_read_b64_tr_b16 a[86:87], v26 offset:29696
    v_fma_f32 v182, v182, s58, v115
    v_fma_f32 v183, v183, s58, v115
    v_exp_f32 v176, v176
    v_exp_f32 v177, v177
    v_exp_f32 v178, v178
    s_waitcnt lgkmcnt(8)
    v_mfma_f32_32x32x16_bf16 v[64:79], a[16:19], v[48:51], v[64:79]
    ds_read_b64_tr_b16 a[88:89], v25 offset:30720
    ds_read_b64_tr_b16 a[90:91], v25 offset:31744
    v_exp_f32 v179, v179
    v_exp_f32 v180, v180
    v_exp_f32 v181, v181
    v_exp_f32 v182, v182
    v_exp_f32 v183, v183
    ds_read_b128 v[32:35], v29 offset:28672
    s_waitcnt lgkmcnt(10)
    v_mfma_f32_32x32x16_bf16 v[80:95], a[16:19], v[52:55], v[80:95]
    s_add_u32 m0, s53, 36864
    s_add_u32 s60, s50, 98304
    buffer_load_dwordx4 v6, s[28:31], s60 offen nt lds
    ds_read_b64_tr_b16 a[92:93], v26 offset:30720
    ds_read_b64_tr_b16 a[94:95], v26 offset:31744
    v_add_f32 v106, v106, v176
    v_add_f32 v107, v107, v177
    v_cvt_pk_bf16_f32 v176, v176, v177
    v_add_f32 v106, v106, v178
    v_add_f32 v107, v107, v179
    ds_read_b128 v[36:39], v29 offset:29696
    v_mfma_f32_32x32x16_bf16 v[128:143], a[20:23], v[48:51], v[128:143]
    v_cvt_pk_bf16_f32 v177, v178, v179
    v_add_f32 v106, v106, v180
    v_add_f32 v107, v107, v181
    v_cvt_pk_bf16_f32 v178, v180, v181
    v_add_f32 v106, v106, v182
    ds_read_b128 v[40:43], v29 offset:30720
    v_mfma_f32_32x32x16_bf16 v[144:159], a[20:23], v[52:55], v[144:159]
    buffer_load_dwordx4 v7, s[28:31], s60 offen offset:1024 nt lds
    v_add_f32 v107, v107, v183
    v_cvt_pk_bf16_f32 v179, v182, v183
    ds_write_b128 v27, v[176:179] offset:33792
    v_fma_f32 v168, v168, s58, v114
    v_fma_f32 v169, v169, s58, v114
    ds_read_b128 v[44:47], v29 offset:31744
    s_waitcnt lgkmcnt(14)
    v_mfma_f32_32x32x16_bf16 v[64:79], a[24:27], v[56:59], v[64:79]
    v_fma_f32 v170, v170, s58, v114
    v_fma_f32 v171, v171, s58, v114
    v_fma_f32 v172, v172, s58, v114
    v_fma_f32 v173, v173, s58, v114
    v_fma_f32 v174, v174, s58, v114
    v_mfma_f32_32x32x16_bf16 v[80:95], a[24:27], v[60:63], v[80:95]
    s_waitcnt lgkmcnt(4)
    v_fma_f32 v175, v175, s58, v114
    v_exp_f32 v168, v168
    v_exp_f32 v169, v169
    v_exp_f32 v170, v170
    v_exp_f32 v171, v171
    v_mfma_f32_32x32x16_bf16 v[128:143], a[28:31], v[56:59], v[128:143]
    buffer_load_dwordx4 v8, s[28:31], s60 offen offset:2048 nt lds
    v_exp_f32 v172, v172
    v_exp_f32 v173, v173
    v_exp_f32 v174, v174
    v_exp_f32 v175, v175
    v_add_f32 v104, v104, v168
    v_mfma_f32_32x32x16_bf16 v[144:159], a[28:31], v[60:63], v[144:159]
    v_add_f32 v105, v105, v169
    v_cvt_pk_bf16_f32 v168, v168, v169
    v_add_f32 v104, v104, v170
    v_add_f32 v105, v105, v171
    v_cvt_pk_bf16_f32 v169, v170, v171
    v_mfma_f32_32x32x16_bf16 v[64:79], a[32:35], v[32:35], v[64:79]
    v_add_f32 v104, v104, v172
    v_add_f32 v105, v105, v173
    v_cvt_pk_bf16_f32 v170, v172, v173
    v_add_f32 v104, v104, v174
    v_add_f32 v105, v105, v175
    ds_read_b128 v[48:51], v30 offset:4096
    s_waitcnt lgkmcnt(4)
    v_mfma_f32_32x32x16_bf16 v[80:95], a[32:35], v[36:39], v[80:95]
    v_cvt_pk_bf16_f32 v171, v174, v175
    ds_write_b128 v27, v[168:171] offset:34816
    v_fma_f32 v184, v184, s58, v115
    v_fma_f32 v185, v185, s58, v115
    v_fma_f32 v186, v186, s58, v115
    ds_read_b128 v[52:55], v30 offset:5120
    v_mfma_f32_32x32x16_bf16 v[128:143], a[36:39], v[32:35], v[128:143]
    buffer_load_dwordx4 v9, s[28:31], s60 offen offset:3072 nt lds
    buffer_load_dword v1, v116, s[36:39], s59 offen
    s_waitcnt vmcnt(13)
    ds_read_b64_tr_b16 a[96:97], v25 offset:8192
    ds_read_b64_tr_b16 a[98:99], v25 offset:9216
    v_fma_f32 v187, v187, s58, v115
    v_fma_f32 v188, v188, s58, v115
    v_fma_f32 v189, v189, s58, v115
    v_fma_f32 v190, v190, s58, v115
    v_fma_f32 v191, v191, s58, v115
    ds_read_b128 v[56:59], v30 offset:6144
    v_mfma_f32_32x32x16_bf16 v[144:159], a[36:39], v[36:39], v[144:159]
    ds_read_b64_tr_b16 a[100:101], v26 offset:8192
    ds_read_b64_tr_b16 a[102:103], v26 offset:9216
    v_exp_f32 v184, v184
    v_exp_f32 v185, v185
    v_exp_f32 v186, v186
    v_exp_f32 v187, v187
    v_exp_f32 v188, v188
    ds_read_b128 v[60:63], v30 offset:7168
    s_waitcnt lgkmcnt(11)
    v_mfma_f32_32x32x16_bf16 v[64:79], a[40:43], v[40:43], v[64:79]
    s_add_u32 m0, s53, 24576
    s_add_u32 s60, s50, 163840
    buffer_load_dwordx4 v6, s[28:31], s60 offen nt lds
    ds_read_b64_tr_b16 a[104:105], v25 offset:10240
    ds_read_b64_tr_b16 a[106:107], v25 offset:11264
    v_exp_f32 v189, v189
    v_exp_f32 v190, v190
    v_exp_f32 v191, v191
    v_add_f32 v106, v106, v184
    v_add_f32 v107, v107, v185
    ds_read_b64_tr_b16 a[108:109], v26 offset:10240
    ds_read_b64_tr_b16 a[110:111], v26 offset:11264
    s_waitcnt lgkmcnt(13)
    v_mfma_f32_32x32x16_bf16 v[80:95], a[40:43], v[44:47], v[80:95]
    v_cvt_pk_bf16_f32 v184, v184, v185
    v_add_f32 v106, v106, v186
    v_add_f32 v107, v107, v187
    v_cvt_pk_bf16_f32 v185, v186, v187
    v_add_f32 v106, v106, v188
    v_mfma_f32_32x32x16_bf16 v[128:143], a[44:47], v[40:43], v[128:143]
    v_add_f32 v107, v107, v189
    v_cvt_pk_bf16_f32 v186, v188, v189
    v_add_f32 v106, v106, v190
    v_add_f32 v107, v107, v191
    v_cvt_pk_bf16_f32 v187, v190, v191
    v_mfma_f32_32x32x16_bf16 v[144:159], a[44:47], v[44:47], v[144:159]
    buffer_load_dwordx4 v7, s[28:31], s60 offen offset:1024 nt lds
    ds_write_b128 v27, v[184:187] offset:35840
    s_waitcnt lgkmcnt(13)
    v_mfma_f32_32x32x16_bf16 v[64:79], a[48:51], v[48:51], v[64:79]
    s_waitcnt lgkmcnt(0)
    s_barrier
    ds_read_b128 v[32:35], v28 offset:32768
    v_mfma_f32_32x32x16_bf16 v[80:95], a[48:51], v[52:55], v[80:95]
    buffer_load_dwordx4 v8, s[28:31], s60 offen offset:2048 nt lds
    ds_read_b128 v[36:39], v28 offset:33792
    v_mfma_f32_32x32x16_bf16 v[128:143], a[52:55], v[48:51], v[128:143]
    ds_read_b128 v[40:43], v28 offset:34816
    v_mfma_f32_32x32x16_bf16 v[144:159], a[52:55], v[52:55], v[144:159]
    ds_read_b128 v[44:47], v28 offset:35840
    v_mfma_f32_32x32x16_bf16 v[64:79], a[56:59], v[56:59], v[64:79]
    v_mfma_f32_32x32x16_bf16 v[80:95], a[56:59], v[60:63], v[80:95]
    buffer_load_dwordx4 v9, s[28:31], s60 offen offset:3072 nt lds
    s_waitcnt vmcnt(13)
    ds_read_b64_tr_b16 a[112:113], v25 offset:16384
    ds_read_b64_tr_b16 a[114:115], v25 offset:17408
    v_mfma_f32_32x32x16_bf16 v[128:143], a[60:63], v[56:59], v[128:143]
    ds_read_b64_tr_b16 a[116:117], v26 offset:16384
    ds_read_b64_tr_b16 a[118:119], v26 offset:17408
    v_mfma_f32_32x32x16_bf16 v[144:159], a[60:63], v[60:63], v[144:159]
    ds_read_b64_tr_b16 a[120:121], v25 offset:18432
    ds_read_b64_tr_b16 a[122:123], v25 offset:19456
    s_waitcnt lgkmcnt(9)
    v_mfma_f32_32x32x16_bf16 v[64:79], a[64:67], v[32:35], v[64:79]
    ds_read_b64_tr_b16 a[124:125], v26 offset:18432
    ds_read_b64_tr_b16 a[126:127], v26 offset:19456
    v_fma_f32 v192, v192, s58, v114
    v_fma_f32 v193, v193, s58, v114
    v_fma_f32 v194, v194, s58, v114
    v_fma_f32 v195, v195, s58, v114
    v_fma_f32 v196, v196, s58, v114
    ds_read_b128 v[48:51], v29 offset:8192
    s_waitcnt lgkmcnt(11)
    v_mfma_f32_32x32x16_bf16 v[80:95], a[64:67], v[36:39], v[80:95]
    s_add_u32 m0, s53, 28672
    s_add_u32 s60, s50, 229376
    buffer_load_dwordx4 v6, s[28:31], s60 offen nt lds
    v_fma_f32 v197, v197, s58, v114
    v_fma_f32 v198, v198, s58, v114
    v_fma_f32 v199, v199, s58, v114
    v_exp_f32 v192, v192
    v_exp_f32 v193, v193
    ds_read_b128 v[52:55], v29 offset:9216
    v_mfma_f32_32x32x16_bf16 v[128:143], a[68:71], v[32:35], v[128:143]
    v_exp_f32 v194, v194
    v_exp_f32 v195, v195
    v_exp_f32 v196, v196
    v_exp_f32 v197, v197
    v_exp_f32 v198, v198
    ds_read_b128 v[56:59], v29 offset:10240
    v_mfma_f32_32x32x16_bf16 v[144:159], a[68:71], v[36:39], v[144:159]
    v_exp_f32 v199, v199
    v_add_f32 v104, v104, v192
    v_add_f32 v105, v105, v193
    v_cvt_pk_bf16_f32 v192, v192, v193
    v_add_f32 v104, v104, v194
    ds_read_b128 v[60:63], v29 offset:11264
    s_waitcnt lgkmcnt(13)
    v_mfma_f32_32x32x16_bf16 v[64:79], a[72:75], v[40:43], v[64:79]
    s_waitcnt lgkmcnt(4)
    buffer_load_dwordx4 v7, s[28:31], s60 offen offset:1024 nt lds
    v_add_f32 v105, v105, v195
    v_cvt_pk_bf16_f32 v193, v194, v195
    v_add_f32 v104, v104, v196
    v_add_f32 v105, v105, v197
    v_cvt_pk_bf16_f32 v194, v196, v197
    v_mfma_f32_32x32x16_bf16 v[80:95], a[72:75], v[44:47], v[80:95]
    v_add_f32 v104, v104, v198
    v_add_f32 v105, v105, v199
    v_cvt_pk_bf16_f32 v195, v198, v199
    ds_write_b128 v27, v[192:195] offset:0
    v_fma_f32 v208, v208, s58, v115
    v_mfma_f32_32x32x16_bf16 v[128:143], a[76:79], v[40:43], v[128:143]
    v_fma_f32 v209, v209, s58, v115
    v_fma_f32 v210, v210, s58, v115
    v_fma_f32 v211, v211, s58, v115
    v_fma_f32 v212, v212, s58, v115
    v_fma_f32 v213, v213, s58, v115
    v_mfma_f32_32x32x16_bf16 v[144:159], a[76:79], v[44:47], v[144:159]
    v_fma_f32 v214, v214, s58, v115
    v_fma_f32 v215, v215, s58, v115
    v_exp_f32 v208, v208
    v_exp_f32 v209, v209
    v_exp_f32 v210, v210
    s_waitcnt lgkmcnt(4)
    v_mfma_f32_32x32x16_bf16 v[64:79], a[80:83], v[48:51], v[64:79]
    buffer_load_dwordx4 v8, s[28:31], s60 offen offset:2048 nt lds
    v_exp_f32 v211, v211
    v_exp_f32 v212, v212
    v_exp_f32 v213, v213
    v_exp_f32 v214, v214
    v_exp_f32 v215, v215
    ds_read_b128 v[32:35], v29 offset:49152
    s_waitcnt lgkmcnt(4)
    v_mfma_f32_32x32x16_bf16 v[80:95], a[80:83], v[52:55], v[80:95]
    v_add_f32 v106, v106, v208
    v_add_f32 v107, v107, v209
    v_cvt_pk_bf16_f32 v208, v208, v209
    v_add_f32 v106, v106, v210
    v_add_f32 v107, v107, v211
    ds_read_b128 v[36:39], v29 offset:50176
    v_mfma_f32_32x32x16_bf16 v[128:143], a[84:87], v[48:51], v[128:143]
    v_cvt_pk_bf16_f32 v209, v210, v211
    v_add_f32 v106, v106, v212
    v_add_f32 v107, v107, v213
    v_cvt_pk_bf16_f32 v210, v212, v213
    v_add_f32 v106, v106, v214
    ds_read_b128 v[40:43], v29 offset:51200
    v_mfma_f32_32x32x16_bf16 v[144:159], a[84:87], v[52:55], v[144:159]
    buffer_load_dwordx4 v9, s[28:31], s60 offen offset:3072 nt lds
    s_waitcnt vmcnt(13)
    ds_read_b64_tr_b16 a[224:225], v25 offset:20480
    ds_read_b64_tr_b16 a[226:227], v25 offset:21504
    v_add_f32 v107, v107, v215
    v_cvt_pk_bf16_f32 v211, v214, v215
    ds_write_b128 v27, v[208:211] offset:1024
    v_fma_f32 v200, v200, s58, v114
    v_fma_f32 v201, v201, s58, v114
    ds_read_b128 v[44:47], v29 offset:52224
    s_waitcnt lgkmcnt(9)
    v_mfma_f32_32x32x16_bf16 v[64:79], a[88:91], v[56:59], v[64:79]
    ds_read_b64_tr_b16 a[228:229], v26 offset:20480
    ds_read_b64_tr_b16 a[230:231], v26 offset:21504
    v_fma_f32 v202, v202, s58, v114
    v_fma_f32 v203, v203, s58, v114
    v_fma_f32 v204, v204, s58, v114
    v_fma_f32 v205, v205, s58, v114
    v_fma_f32 v206, v206, s58, v114
    ds_read_b64_tr_b16 a[232:233], v25 offset:22528
    ds_read_b64_tr_b16 a[234:235], v25 offset:23552
    ds_read_b64_tr_b16 a[236:237], v26 offset:22528
    ds_read_b64_tr_b16 a[238:239], v26 offset:23552
    s_waitcnt lgkmcnt(14)
    v_mfma_f32_32x32x16_bf16 v[80:95], a[88:91], v[60:63], v[80:95]
    s_add_u32 m0, s53, 8192
    s_add_u32 s60, s51, 49152
    buffer_load_dwordx4 v6, s[28:31], s60 offen nt lds
    v_fma_f32 v207, v207, s58, v114
    v_exp_f32 v200, v200
    v_exp_f32 v201, v201
    v_exp_f32 v202, v202
    v_exp_f32 v203, v203
    v_mfma_f32_32x32x16_bf16 v[128:143], a[92:95], v[56:59], v[128:143]
    v_exp_f32 v204, v204
    v_exp_f32 v205, v205
    v_exp_f32 v206, v206
    v_exp_f32 v207, v207
    v_add_f32 v104, v104, v200
    v_mfma_f32_32x32x16_bf16 v[144:159], a[92:95], v[60:63], v[144:159]
    v_add_f32 v105, v105, v201
    v_cvt_pk_bf16_f32 v200, v200, v201
    v_add_f32 v104, v104, v202
    v_add_f32 v105, v105, v203
    v_cvt_pk_bf16_f32 v201, v202, v203
    s_waitcnt lgkmcnt(12)
    v_mfma_f32_32x32x16_bf16 v[64:79], a[96:99], v[32:35], v[64:79]
    buffer_load_dwordx4 v7, s[28:31], s60 offen offset:1024 nt lds
    v_add_f32 v104, v104, v204
    v_add_f32 v105, v105, v205
    v_cvt_pk_bf16_f32 v202, v204, v205
    v_add_f32 v104, v104, v206
    v_add_f32 v105, v105, v207
    ds_read_b128 v[48:51], v30 offset:24576
    s_waitcnt lgkmcnt(12)
    v_mfma_f32_32x32x16_bf16 v[80:95], a[96:99], v[36:39], v[80:95]
    s_waitcnt lgkmcnt(1)
    v_cvt_pk_bf16_f32 v203, v206, v207
    ds_write_b128 v27, v[200:203] offset:2048
    v_fma_f32 v216, v216, s58, v115
    v_fma_f32 v217, v217, s58, v115
    v_fma_f32 v218, v218, s58, v115
    ds_read_b128 v[52:55], v30 offset:25600
    v_mfma_f32_32x32x16_bf16 v[128:143], a[100:103], v[32:35], v[128:143]
    v_fma_f32 v219, v219, s58, v115
    v_fma_f32 v220, v220, s58, v115
    v_fma_f32 v221, v221, s58, v115
    v_fma_f32 v222, v222, s58, v115
    v_fma_f32 v223, v223, s58, v115
    ds_read_b128 v[56:59], v30 offset:26624
    v_mfma_f32_32x32x16_bf16 v[144:159], a[100:103], v[36:39], v[144:159]
    buffer_load_dwordx4 v8, s[28:31], s60 offen offset:2048 nt lds
    v_exp_f32 v216, v216
    v_exp_f32 v217, v217
    v_exp_f32 v218, v218
    v_exp_f32 v219, v219
    v_exp_f32 v220, v220
    ds_read_b128 v[60:63], v30 offset:27648
    v_mfma_f32_32x32x16_bf16 v[64:79], a[104:107], v[40:43], v[64:79]
    v_exp_f32 v221, v221
    v_exp_f32 v222, v222
    v_exp_f32 v223, v223
    v_add_f32 v106, v106, v216
    v_add_f32 v107, v107, v217
    v_mfma_f32_32x32x16_bf16 v[80:95], a[104:107], v[44:47], v[80:95]
    v_cvt_pk_bf16_f32 v216, v216, v217
    v_add_f32 v106, v106, v218
    v_add_f32 v107, v107, v219
    v_cvt_pk_bf16_f32 v217, v218, v219
    v_add_f32 v106, v106, v220
    v_mfma_f32_32x32x16_bf16 v[128:143], a[108:111], v[40:43], v[128:143]
    buffer_load_dwordx4 v9, s[28:31], s60 offen offset:3072 nt lds
    s_waitcnt vmcnt(13)
    ds_read_b64_tr_b16 a[240:241], v25 offset:36864
    ds_read_b64_tr_b16 a[242:243], v25 offset:37888
    v_add_f32 v107, v107, v221
    v_cvt_pk_bf16_f32 v218, v220, v221
    v_add_f32 v106, v106, v222
    v_add_f32 v107, v107, v223
    v_cvt_pk_bf16_f32 v219, v222, v223
    v_mfma_f32_32x32x16_bf16 v[144:159], a[108:111], v[44:47], v[144:159]
    ds_read_b64_tr_b16 a[244:245], v26 offset:36864
    ds_read_b64_tr_b16 a[246:247], v26 offset:37888
    ds_write_b128 v27, v[216:219] offset:3072
    s_waitcnt lgkmcnt(9)
    v_mfma_f32_32x32x16_bf16 v[64:79], a[112:115], v[48:51], v[64:79]
    ds_read_b64_tr_b16 a[248:249], v25 offset:38912
    ds_read_b64_tr_b16 a[250:251], v25 offset:39936
    ds_read_b64_tr_b16 a[252:253], v26 offset:38912
    ds_read_b64_tr_b16 a[254:255], v26 offset:39936
    s_waitcnt lgkmcnt(0)
    s_barrier
    ds_read_b128 v[32:35], v28 offset:0
    v_mfma_f32_32x32x16_bf16 v[80:95], a[112:115], v[52:55], v[80:95]
    s_add_u32 m0, s53, 16384
    s_add_u32 s60, s51, 114688
    buffer_load_dwordx4 v6, s[28:31], s60 offen nt lds
    ds_read_b128 v[36:39], v28 offset:1024
    v_mfma_f32_32x32x16_bf16 v[128:143], a[116:119], v[48:51], v[128:143]
    ds_read_b128 v[40:43], v28 offset:2048
    v_mfma_f32_32x32x16_bf16 v[144:159], a[116:119], v[52:55], v[144:159]
    ds_read_b128 v[44:47], v28 offset:3072
    v_mfma_f32_32x32x16_bf16 v[64:79], a[120:123], v[56:59], v[64:79]
    buffer_load_dwordx4 v7, s[28:31], s60 offen offset:1024 nt lds
    v_mfma_f32_32x32x16_bf16 v[80:95], a[120:123], v[60:63], v[80:95]
    v_mfma_f32_32x32x16_bf16 v[128:143], a[124:127], v[56:59], v[128:143]
    v_mfma_f32_32x32x16_bf16 v[144:159], a[124:127], v[60:63], v[144:159]
    s_waitcnt lgkmcnt(3)
    v_mfma_f32_32x32x16_bf16 v[64:79], a[224:227], v[32:35], v[64:79]
    buffer_load_dwordx4 v8, s[28:31], s60 offen offset:2048 nt lds
    v_fma_f32 v224, v224, s58, v114
    v_fma_f32 v225, v225, s58, v114
    v_fma_f32 v226, v226, s58, v114
    v_fma_f32 v227, v227, s58, v114
    v_fma_f32 v228, v228, s58, v114
    ds_read_b128 v[48:51], v28 offset:40960
    s_waitcnt lgkmcnt(3)
    v_mfma_f32_32x32x16_bf16 v[80:95], a[224:227], v[36:39], v[80:95]
    v_fma_f32 v229, v229, s58, v114
    v_fma_f32 v230, v230, s58, v114
    v_fma_f32 v231, v231, s58, v114
    v_exp_f32 v224, v224
    v_exp_f32 v225, v225
    ds_read_b128 v[52:55], v28 offset:41984
    v_mfma_f32_32x32x16_bf16 v[128:143], a[228:231], v[32:35], v[128:143]
    v_exp_f32 v226, v226
    v_exp_f32 v227, v227
    v_exp_f32 v228, v228
    v_exp_f32 v229, v229
    v_exp_f32 v230, v230
    ds_read_b128 v[56:59], v28 offset:43008
    v_mfma_f32_32x32x16_bf16 v[144:159], a[228:231], v[36:39], v[144:159]
    buffer_load_dwordx4 v9, s[28:31], s60 offen offset:3072 nt lds
    s_waitcnt vmcnt(12)
    ds_read_b64_tr_b16 a[128:129], v25 offset:24576
    ds_read_b64_tr_b16 a[130:131], v25 offset:25600
    v_exp_f32 v231, v231
    v_add_f32 v104, v104, v224
    v_add_f32 v105, v105, v225
    v_cvt_pk_bf16_f32 v224, v224, v225
    v_add_f32 v104, v104, v226
    ds_read_b128 v[60:63], v28 offset:44032
    s_waitcnt lgkmcnt(7)
    v_mfma_f32_32x32x16_bf16 v[64:79], a[232:235], v[40:43], v[64:79]
    ds_read_b64_tr_b16 a[132:133], v26 offset:24576
    ds_read_b64_tr_b16 a[134:135], v26 offset:25600
    v_add_f32 v105, v105, v227
    v_cvt_pk_bf16_f32 v225, v226, v227
    v_add_f32 v104, v104, v228
    v_add_f32 v105, v105, v229
    v_cvt_pk_bf16_f32 v226, v228, v229
    ds_read_b64_tr_b16 a[136:137], v25 offset:26624
    ds_read_b64_tr_b16 a[138:139], v25 offset:27648
    ds_read_b64_tr_b16 a[140:141], v26 offset:26624
    ds_read_b64_tr_b16 a[142:143], v26 offset:27648
    s_waitcnt lgkmcnt(12)
    v_mfma_f32_32x32x16_bf16 v[80:95], a[232:235], v[44:47], v[80:95]
    v_add_f32 v104, v104, v230
    v_add_f32 v105, v105, v231
    v_cvt_pk_bf16_f32 v227, v230, v231
    ds_write_b128 v27, v[224:227] offset:4096
    v_fma_f32 v240, v240, s58, v115
    v_mfma_f32_32x32x16_bf16 v[128:143], a[236:239], v[40:43], v[128:143]
    s_add_u32 m0, s53, 20480
    s_add_u32 s60, s51, 180224
    buffer_load_dwordx4 v6, s[28:31], s60 offen nt lds
    v_fma_f32 v241, v241, s58, v115
    v_fma_f32 v242, v242, s58, v115
    v_fma_f32 v243, v243, s58, v115
    v_fma_f32 v244, v244, s58, v115
    v_fma_f32 v245, v245, s58, v115
    v_mfma_f32_32x32x16_bf16 v[144:159], a[236:239], v[44:47], v[144:159]
    v_fma_f32 v246, v246, s58, v115
    v_fma_f32 v247, v247, s58, v115
    v_exp_f32 v240, v240
    v_exp_f32 v241, v241
    v_exp_f32 v242, v242
    s_waitcnt lgkmcnt(12)
    v_mfma_f32_32x32x16_bf16 v[64:79], a[240:243], v[48:51], v[64:79]
    v_exp_f32 v243, v243
    v_exp_f32 v244, v244
    v_exp_f32 v245, v245
    v_exp_f32 v246, v246
    v_exp_f32 v247, v247
    ds_read_b128 v[32:35], v29 offset:16384
    s_waitcnt lgkmcnt(12)
    v_mfma_f32_32x32x16_bf16 v[80:95], a[240:243], v[52:55], v[80:95]
    s_waitcnt lgkmcnt(2)
    buffer_load_dwordx4 v7, s[28:31], s60 offen offset:1024 nt lds
    v_add_f32 v106, v106, v240
    v_add_f32 v107, v107, v241
    v_cvt_pk_bf16_f32 v240, v240, v241
    v_add_f32 v106, v106, v242
    v_add_f32 v107, v107, v243
    ds_read_b128 v[36:39], v29 offset:17408
    v_mfma_f32_32x32x16_bf16 v[128:143], a[244:247], v[48:51], v[128:143]
    v_cvt_pk_bf16_f32 v241, v242, v243
    v_add_f32 v106, v106, v244
    v_add_f32 v107, v107, v245
    v_cvt_pk_bf16_f32 v242, v244, v245
    v_add_f32 v106, v106, v246
    ds_read_b128 v[40:43], v29 offset:18432
    v_mfma_f32_32x32x16_bf16 v[144:159], a[244:247], v[52:55], v[144:159]
    v_add_f32 v107, v107, v247
    v_cvt_pk_bf16_f32 v243, v246, v247
    ds_write_b128 v27, v[240:243] offset:5120
    v_fma_f32 v232, v232, s58, v114
    v_fma_f32 v233, v233, s58, v114
    ds_read_b128 v[44:47], v29 offset:19456
    v_mfma_f32_32x32x16_bf16 v[64:79], a[248:251], v[56:59], v[64:79]
    buffer_load_dwordx4 v8, s[28:31], s60 offen offset:2048 nt lds
    v_fma_f32 v234, v234, s58, v114
    v_fma_f32 v235, v235, s58, v114
    v_fma_f32 v236, v236, s58, v114
    v_fma_f32 v237, v237, s58, v114
    v_fma_f32 v238, v238, s58, v114
    v_mfma_f32_32x32x16_bf16 v[80:95], a[248:251], v[60:63], v[80:95]
    v_fma_f32 v239, v239, s58, v114
    v_exp_f32 v232, v232
    v_exp_f32 v233, v233
    v_exp_f32 v234, v234
    v_exp_f32 v235, v235
    v_mfma_f32_32x32x16_bf16 v[128:143], a[252:255], v[56:59], v[128:143]
    v_exp_f32 v236, v236
    v_exp_f32 v237, v237
    v_exp_f32 v238, v238
    v_exp_f32 v239, v239
    v_add_f32 v104, v104, v232
    v_mfma_f32_32x32x16_bf16 v[144:159], a[252:255], v[60:63], v[144:159]
    buffer_load_dwordx4 v9, s[28:31], s60 offen offset:3072 nt lds
    s_waitcnt vmcnt(12)
    ds_read_b64_tr_b16 a[144:145], v25 offset:28672
    ds_read_b64_tr_b16 a[146:147], v25 offset:29696
    v_add_f32 v105, v105, v233
    v_cvt_pk_bf16_f32 v232, v232, v233
    v_add_f32 v104, v104, v234
    v_add_f32 v105, v105, v235
    v_cvt_pk_bf16_f32 v233, v234, v235
    s_waitcnt lgkmcnt(6)
    v_mfma_f32_32x32x16_bf16 v[64:79], a[128:131], v[32:35], v[64:79]
    ds_read_b64_tr_b16 a[148:149], v26 offset:28672
    ds_read_b64_tr_b16 a[150:151], v26 offset:29696
    v_add_f32 v104, v104, v236
    v_add_f32 v105, v105, v237
    v_cvt_pk_bf16_f32 v234, v236, v237
    v_add_f32 v104, v104, v238
    v_add_f32 v105, v105, v239
    ds_read_b128 v[48:51], v29 offset:57344
    s_waitcnt lgkmcnt(8)
    v_mfma_f32_32x32x16_bf16 v[80:95], a[128:131], v[36:39], v[80:95]
    ds_read_b64_tr_b16 a[152:153], v25 offset:30720
    ds_read_b64_tr_b16 a[154:155], v25 offset:31744
    v_cvt_pk_bf16_f32 v235, v238, v239
    ds_write_b128 v27, v[232:235] offset:6144
    v_fma_f32 v248, v248, s58, v115
    v_fma_f32 v249, v249, s58, v115
    v_fma_f32 v250, v250, s58, v115
    ds_read_b128 v[52:55], v29 offset:58368
    v_mfma_f32_32x32x16_bf16 v[128:143], a[132:135], v[32:35], v[128:143]
    s_add_u32 m0, s53, 36864
    s_add_u32 s60, s51, 245760
    buffer_load_dwordx4 v6, s[28:31], s60 offen nt lds
    ds_read_b64_tr_b16 a[156:157], v26 offset:30720
    ds_read_b64_tr_b16 a[158:159], v26 offset:31744
    v_fma_f32 v251, v251, s58, v115
    v_fma_f32 v252, v252, s58, v115
    v_fma_f32 v253, v253, s58, v115
    v_fma_f32 v254, v254, s58, v115
    v_fma_f32 v255, v255, s58, v115
    ds_read_b128 v[56:59], v29 offset:59392
    v_mfma_f32_32x32x16_bf16 v[144:159], a[132:135], v[36:39], v[144:159]
    v_exp_f32 v248, v248
    v_exp_f32 v249, v249
    v_exp_f32 v250, v250
    v_exp_f32 v251, v251
    v_exp_f32 v252, v252
    ds_read_b128 v[60:63], v29 offset:60416
    s_waitcnt lgkmcnt(14)
    v_mfma_f32_32x32x16_bf16 v[64:79], a[136:139], v[40:43], v[64:79]
    buffer_load_dwordx4 v7, s[28:31], s60 offen offset:1024 nt lds
    v_exp_f32 v253, v253
    v_exp_f32 v254, v254
    v_exp_f32 v255, v255
    v_add_f32 v106, v106, v248
    v_add_f32 v107, v107, v249
    s_waitcnt lgkmcnt(13)
    v_mfma_f32_32x32x16_bf16 v[80:95], a[136:139], v[44:47], v[80:95]
    v_cvt_pk_bf16_f32 v248, v248, v249
    v_add_f32 v106, v106, v250
    v_add_f32 v107, v107, v251
    v_cvt_pk_bf16_f32 v249, v250, v251
    v_add_f32 v106, v106, v252
    v_mfma_f32_32x32x16_bf16 v[128:143], a[140:143], v[40:43], v[128:143]
    s_waitcnt lgkmcnt(2)
    v_add_f32 v107, v107, v253
    v_cvt_pk_bf16_f32 v250, v252, v253
    v_add_f32 v106, v106, v254
    v_add_f32 v107, v107, v255
    v_cvt_pk_bf16_f32 v251, v254, v255
    v_mfma_f32_32x32x16_bf16 v[144:159], a[140:143], v[44:47], v[144:159]
    ds_write_b128 v27, v[248:251] offset:7168
    v_mfma_f32_32x32x16_bf16 v[64:79], a[144:147], v[48:51], v[64:79]
    buffer_load_dwordx4 v8, s[28:31], s60 offen offset:2048 nt lds
    s_waitcnt lgkmcnt(0)
    s_barrier
    ds_read_b128 v[32:35], v28 offset:4096
    v_mfma_f32_32x32x16_bf16 v[80:95], a[144:147], v[52:55], v[80:95]
    ds_read_b128 v[36:39], v28 offset:5120
    v_mfma_f32_32x32x16_bf16 v[128:143], a[148:151], v[48:51], v[128:143]
    buffer_load_dwordx4 v9, s[28:31], s60 offen offset:3072 nt lds
    s_waitcnt vmcnt(12)
    ds_read_b64_tr_b16 a[160:161], v25 offset:8192
    ds_read_b64_tr_b16 a[162:163], v25 offset:9216
    ds_read_b128 v[40:43], v28 offset:6144
    v_mfma_f32_32x32x16_bf16 v[144:159], a[148:151], v[52:55], v[144:159]
    ds_read_b64_tr_b16 a[164:165], v26 offset:8192
    ds_read_b64_tr_b16 a[166:167], v26 offset:9216
    ds_read_b128 v[44:47], v28 offset:7168
    v_mfma_f32_32x32x16_bf16 v[64:79], a[152:155], v[56:59], v[64:79]
    ds_read_b64_tr_b16 a[168:169], v25 offset:10240
    ds_read_b64_tr_b16 a[170:171], v25 offset:11264
    ds_read_b64_tr_b16 a[172:173], v26 offset:10240
    ds_read_b64_tr_b16 a[174:175], v26 offset:11264
    v_mfma_f32_32x32x16_bf16 v[80:95], a[152:155], v[60:63], v[80:95]
    v_mfma_f32_32x32x16_bf16 v[128:143], a[156:159], v[56:59], v[128:143]
    v_mfma_f32_32x32x16_bf16 v[144:159], a[156:159], v[60:63], v[144:159]
    s_waitcnt lgkmcnt(8)
    v_mfma_f32_32x32x16_bf16 v[64:79], a[160:163], v[32:35], v[64:79]
    v_add_f32 v104, v104, v105
    v_add_f32 v106, v106, v107
    s_nop 1
    v_permlane32_swap_b32 v104, v106
    v_add_f32 v104, v104, v106
    ds_read_b128 v[48:51], v28 offset:45056
    v_mfma_f32_32x32x16_bf16 v[80:95], a[160:163], v[36:39], v[80:95]
    ds_read_b128 v[52:55], v28 offset:46080
    s_waitcnt lgkmcnt(7)
    v_mfma_f32_32x32x16_bf16 v[128:143], a[164:167], v[32:35], v[128:143]
    s_waitcnt lgkmcnt(2)
    ds_read_b128 v[56:59], v28 offset:47104
    v_mfma_f32_32x32x16_bf16 v[144:159], a[164:167], v[36:39], v[144:159]
    ds_read_b128 v[60:63], v28 offset:48128
    v_mfma_f32_32x32x16_bf16 v[64:79], a[168:171], v[40:43], v[64:79]
    s_waitcnt vmcnt(8)
    ds_read_b64_tr_b16 a[176:177], v25 offset:16384
    ds_read_b64_tr_b16 a[178:179], v25 offset:17408
    ds_read_b64_tr_b16 a[180:181], v26 offset:16384
    ds_read_b64_tr_b16 a[182:183], v26 offset:17408
    ds_read_b64_tr_b16 a[184:185], v25 offset:18432
    ds_read_b64_tr_b16 a[186:187], v25 offset:19456
    ds_read_b64_tr_b16 a[188:189], v26 offset:18432
    ds_read_b64_tr_b16 a[190:191], v26 offset:19456
    v_mfma_f32_32x32x16_bf16 v[80:95], a[168:171], v[44:47], v[80:95]
    v_mfma_f32_32x32x16_bf16 v[128:143], a[172:175], v[40:43], v[128:143]
    v_mfma_f32_32x32x16_bf16 v[144:159], a[172:175], v[44:47], v[144:159]
    s_waitcnt lgkmcnt(6)
    v_mfma_f32_32x32x16_bf16 v[64:79], a[176:179], v[48:51], v[64:79]
    ds_read_b128 v[32:35], v29 offset:20480
    v_mfma_f32_32x32x16_bf16 v[80:95], a[176:179], v[52:55], v[80:95]
    ds_read_b128 v[36:39], v29 offset:21504
    s_waitcnt lgkmcnt(6)
    v_mfma_f32_32x32x16_bf16 v[128:143], a[180:183], v[48:51], v[128:143]
    s_waitcnt lgkmcnt(2)
    s_add_u32 m0, s53, 24576
    s_add_u32 s60, s92, 0
    buffer_load_dwordx4 v14, s[36:39], s60 offen lds
    ds_read_b128 v[40:43], v29 offset:22528
    v_mfma_f32_32x32x16_bf16 v[144:159], a[180:183], v[52:55], v[144:159]
    buffer_load_dwordx4 v15, s[36:39], s60 offen offset:1024 lds
    ds_read_b128 v[44:47], v29 offset:23552
    v_mfma_f32_32x32x16_bf16 v[64:79], a[184:187], v[56:59], v[64:79]
    buffer_load_dwordx4 v16, s[36:39], s60 offen offset:2048 lds
    buffer_load_dwordx4 v17, s[36:39], s60 offen offset:3072 lds
    s_waitcnt vmcnt(8)
    ds_read_b64_tr_b16 a[192:193], v25 offset:20480
    ds_read_b64_tr_b16 a[194:195], v25 offset:21504
    ds_read_b64_tr_b16 a[196:197], v26 offset:20480
    ds_read_b64_tr_b16 a[198:199], v26 offset:21504
    ds_read_b64_tr_b16 a[200:201], v25 offset:22528
    ds_read_b64_tr_b16 a[202:203], v25 offset:23552
    ds_read_b64_tr_b16 a[204:205], v26 offset:22528
    ds_read_b64_tr_b16 a[206:207], v26 offset:23552
    v_mfma_f32_32x32x16_bf16 v[80:95], a[184:187], v[60:63], v[80:95]
    v_mfma_f32_32x32x16_bf16 v[128:143], a[188:191], v[56:59], v[128:143]
    v_mfma_f32_32x32x16_bf16 v[144:159], a[188:191], v[60:63], v[144:159]
    s_waitcnt lgkmcnt(6)
    v_mfma_f32_32x32x16_bf16 v[64:79], a[192:195], v[32:35], v[64:79]
    ds_read_b128 v[48:51], v29 offset:61440
    v_mfma_f32_32x32x16_bf16 v[80:95], a[192:195], v[36:39], v[80:95]
    ds_read_b128 v[52:55], v29 offset:62464
    s_waitcnt lgkmcnt(6)
    v_mfma_f32_32x32x16_bf16 v[128:143], a[196:199], v[32:35], v[128:143]
    s_waitcnt lgkmcnt(2)
    s_add_u32 m0, s53, 28672
    s_add_u32 s60, s92, 28672
    buffer_load_dwordx4 v14, s[36:39], s60 offen lds
    ds_read_b128 v[56:59], v29 offset:63488
    v_mfma_f32_32x32x16_bf16 v[144:159], a[196:199], v[36:39], v[144:159]
    buffer_load_dwordx4 v15, s[36:39], s60 offen offset:1024 lds
    ds_read_b128 v[60:63], v29 offset:64512
    v_mfma_f32_32x32x16_bf16 v[64:79], a[200:203], v[40:43], v[64:79]
    buffer_load_dwordx4 v16, s[36:39], s60 offen offset:2048 lds
    buffer_load_dwordx4 v17, s[36:39], s60 offen offset:3072 lds
    s_waitcnt vmcnt(8)
    ds_read_b64_tr_b16 a[208:209], v25 offset:36864
    ds_read_b64_tr_b16 a[210:211], v25 offset:37888
    ds_read_b64_tr_b16 a[212:213], v26 offset:36864
    ds_read_b64_tr_b16 a[214:215], v26 offset:37888
    ds_read_b64_tr_b16 a[216:217], v25 offset:38912
    ds_read_b64_tr_b16 a[218:219], v25 offset:39936
    ds_read_b64_tr_b16 a[220:221], v26 offset:38912
    ds_read_b64_tr_b16 a[222:223], v26 offset:39936
    v_mfma_f32_32x32x16_bf16 v[80:95], a[200:203], v[44:47], v[80:95]
    v_mfma_f32_32x32x16_bf16 v[128:143], a[204:207], v[40:43], v[128:143]
    v_mfma_f32_32x32x16_bf16 v[144:159], a[204:207], v[44:47], v[144:159]
    s_waitcnt lgkmcnt(6)
    v_mfma_f32_32x32x16_bf16 v[64:79], a[208:211], v[48:51], v[64:79]
    v_mfma_f32_32x32x16_bf16 v[80:95], a[208:211], v[52:55], v[80:95]
    s_waitcnt vmcnt(4)
    ds_read_b64_tr_b16 a[0:1], v23 offset:24576
    ds_read_b64_tr_b16 a[2:3], v23 offset:25088
    ds_write_b32 v31, v104 offset:20480
    s_waitcnt lgkmcnt(7)
    v_mfma_f32_32x32x16_bf16 v[128:143], a[212:215], v[48:51], v[128:143]
    s_waitcnt lgkmcnt(3)
    s_add_u32 m0, s53, 36864
    s_add_u32 s60, s93, 0
    buffer_load_dwordx4 v14, s[36:39], s60 offen lds
    ds_read_b64_tr_b16 a[4:5], v24 offset:24576
    ds_read_b64_tr_b16 a[6:7], v24 offset:25088
    v_mfma_f32_32x32x16_bf16 v[144:159], a[212:215], v[52:55], v[144:159]
    buffer_load_dwordx4 v15, s[36:39], s60 offen offset:1024 lds
    ds_read_b64_tr_b16 a[8:9], v23 offset:26624
    ds_read_b64_tr_b16 a[10:11], v23 offset:27136
    v_mfma_f32_32x32x16_bf16 v[64:79], a[216:219], v[56:59], v[64:79]
    buffer_load_dwordx4 v16, s[36:39], s60 offen offset:2048 lds
    ds_read_b64_tr_b16 a[12:13], v24 offset:26624
    ds_read_b64_tr_b16 a[14:15], v24 offset:27136
    v_mfma_f32_32x32x16_bf16 v[80:95], a[216:219], v[60:63], v[80:95]
    buffer_load_dwordx4 v17, s[36:39], s60 offen offset:3072 lds
    v_mfma_f32_32x32x16_bf16 v[128:143], a[220:223], v[56:59], v[128:143]
    s_waitcnt vmcnt(4)
    ds_read_b64_tr_b16 a[16:17], v23 offset:28672
    ds_read_b64_tr_b16 a[18:19], v23 offset:29184
    v_mfma_f32_32x32x16_bf16 v[144:159], a[220:223], v[60:63], v[144:159]
    ds_read_b64_tr_b16 a[20:21], v24 offset:28672
    ds_read_b64_tr_b16 a[22:23], v24 offset:29184
    v_cvt_pk_bf16_f32 v32, v64, v65
    ds_read_b64_tr_b16 a[24:25], v23 offset:30720
    v_cvt_pk_bf16_f32 v33, v66, v67
    ds_read_b64_tr_b16 a[26:27], v23 offset:31232
    v_cvt_pk_bf16_f32 v34, v68, v69
    ds_read_b64_tr_b16 a[28:29], v24 offset:30720
    v_cvt_pk_bf16_f32 v35, v70, v71
    ds_read_b64_tr_b16 a[30:31], v24 offset:31232
    ds_write_b128 v27, v[32:35] offset:8192
    v_cvt_pk_bf16_f32 v36, v80, v81
    v_cvt_pk_bf16_f32 v37, v82, v83
    v_cvt_pk_bf16_f32 v38, v84, v85
    v_cvt_pk_bf16_f32 v39, v86, v87
    ds_write_b128 v27, v[36:39] offset:9216
    s_waitcnt lgkmcnt(10)
    s_add_u32 m0, s53, 24576
    s_add_u32 s60, s93, 28672
    buffer_load_dwordx4 v14, s[36:39], s60 offen lds
    v_cvt_pk_bf16_f32 v40, v72, v73
    buffer_load_dwordx4 v15, s[36:39], s60 offen offset:1024 lds
    v_cvt_pk_bf16_f32 v41, v74, v75
    buffer_load_dwordx4 v16, s[36:39], s60 offen offset:2048 lds
    v_cvt_pk_bf16_f32 v42, v76, v77
    buffer_load_dwordx4 v17, s[36:39], s60 offen offset:3072 lds
    v_cvt_pk_bf16_f32 v43, v78, v79
    ds_write_b128 v27, v[40:43] offset:10240
    v_cvt_pk_bf16_f32 v44, v88, v89
    v_cvt_pk_bf16_f32 v45, v90, v91
    v_cvt_pk_bf16_f32 v46, v92, v93
    v_cvt_pk_bf16_f32 v47, v94, v95
    ds_write_b128 v27, v[44:47] offset:11264
    s_waitcnt lgkmcnt(4)
    s_add_u32 m0, s53, 28672
    s_add_u32 s60, s94, 0
    buffer_load_dwordx4 v14, s[36:39], s60 offen lds
    v_cvt_pk_bf16_f32 v48, v128, v129
    buffer_load_dwordx4 v15, s[36:39], s60 offen offset:1024 lds
    v_cvt_pk_bf16_f32 v49, v130, v131
    buffer_load_dwordx4 v16, s[36:39], s60 offen offset:2048 lds
    v_cvt_pk_bf16_f32 v50, v132, v133
    buffer_load_dwordx4 v17, s[36:39], s60 offen offset:3072 lds
    v_cvt_pk_bf16_f32 v51, v134, v135
    ds_write_b128 v27, v[48:51] offset:16384
    v_cvt_pk_bf16_f32 v52, v144, v145
    v_cvt_pk_bf16_f32 v53, v146, v147
    v_cvt_pk_bf16_f32 v54, v148, v149
    v_cvt_pk_bf16_f32 v55, v150, v151
    ds_write_b128 v27, v[52:55] offset:17408
    v_cvt_pk_bf16_f32 v56, v136, v137
    v_cvt_pk_bf16_f32 v57, v138, v139
    v_cvt_pk_bf16_f32 v58, v140, v141
    v_cvt_pk_bf16_f32 v59, v142, v143
    ds_write_b128 v27, v[56:59] offset:18432
    v_cvt_pk_bf16_f32 v60, v152, v153
    v_cvt_pk_bf16_f32 v61, v154, v155
    v_cvt_pk_bf16_f32 v62, v156, v157
    v_cvt_pk_bf16_f32 v63, v158, v159
    ds_write_b128 v27, v[60:63] offset:19456
    v_mfma_f32_32x32x16_bf16 v[192:207], a[0:3], v[32:35], 0
    v_mfma_f32_32x32x16_bf16 v[208:223], a[0:3], v[36:39], 0
    s_waitcnt vmcnt(8)
    ds_read_b64_tr_b16 a[224:225], v23 offset:36864
    ds_read_b64_tr_b16 a[226:227], v23 offset:37376
    v_mfma_f32_32x32x16_bf16 v[192:207], a[8:11], v[40:43], v[192:207]
    ds_read_b64_tr_b16 a[228:229], v24 offset:36864
    ds_read_b64_tr_b16 a[230:231], v24 offset:37376
    v_mfma_f32_32x32x16_bf16 v[208:223], a[8:11], v[44:47], v[208:223]
    ds_read_b64_tr_b16 a[232:233], v23 offset:38912
    ds_read_b64_tr_b16 a[234:235], v23 offset:39424
    v_mfma_f32_32x32x16_bf16 v[224:239], a[4:7], v[32:35], 0
    ds_read_b64_tr_b16 a[236:237], v24 offset:38912
    ds_read_b64_tr_b16 a[238:239], v24 offset:39424
    v_mfma_f32_32x32x16_bf16 v[240:255], a[4:7], v[36:39], 0
    s_waitcnt lgkmcnt(0)
    s_barrier
    ds_read_b128 a[32:35], v121 offset:8192
    ds_read_b128 a[36:39], v121 offset:9216
    v_mfma_f32_32x32x16_bf16 v[224:239], a[12:15], v[40:43], v[224:239]
    s_add_u32 m0, s53, 12288
    s_add_u32 s60, s94, 28672
    buffer_load_dwordx4 v14, s[36:39], s60 offen lds
    ds_read_b128 a[40:43], v121 offset:10240
    ds_read_b128 a[44:47], v121 offset:11264
    v_mfma_f32_32x32x16_bf16 v[240:255], a[12:15], v[44:47], v[240:255]
    buffer_load_dwordx4 v15, s[36:39], s60 offen offset:1024 lds
    s_waitcnt vmcnt(6)
    ds_read_b64_tr_b16 a[240:241], v23 offset:24576
    ds_read_b64_tr_b16 a[242:243], v23 offset:25088
    ds_read_b128 a[48:51], v121 offset:16384
    ds_read_b128 a[52:55], v121 offset:17408
    v_mfma_f32_32x32x16_bf16 v[192:207], a[16:19], v[48:51], v[192:207]
    buffer_load_dwordx4 v16, s[36:39], s60 offen offset:2048 lds
    ds_read_b64_tr_b16 a[244:245], v24 offset:24576
    ds_read_b64_tr_b16 a[246:247], v24 offset:25088
    ds_read_b128 a[56:59], v121 offset:18432
    ds_read_b128 a[60:63], v121 offset:19456
    v_mfma_f32_32x32x16_bf16 v[208:223], a[16:19], v[52:55], v[208:223]
    buffer_load_dwordx4 v17, s[36:39], s60 offen offset:3072 lds
    ds_read_b64_tr_b16 a[248:249], v23 offset:26624
    ds_read_b64_tr_b16 a[250:251], v23 offset:27136
    ds_read_b128 a[64:67], v122 offset:8192
    ds_read_b128 a[68:71], v122 offset:9216
    v_mfma_f32_32x32x16_bf16 v[192:207], a[24:27], v[56:59], v[192:207]
    s_add_u32 m0, s53, 32768
    s_add_u32 s60, s95, 0
    buffer_load_dwordx4 v14, s[36:39], s60 offen lds
    ds_read_b64_tr_b16 a[252:253], v24 offset:26624
    ds_read_b64_tr_b16 a[254:255], v24 offset:27136
    ds_read_b128 a[72:75], v122 offset:10240
    ds_read_b128 a[76:79], v122 offset:11264
    v_mfma_f32_32x32x16_bf16 v[208:223], a[24:27], v[60:63], v[208:223]
    buffer_load_dwordx4 v15, s[36:39], s60 offen offset:1024 lds
    s_waitcnt vmcnt(6)
    ds_read_b64_tr_b16 a[128:129], v23 offset:28672
    ds_read_b64_tr_b16 a[130:131], v23 offset:29184
    ds_read_b128 a[80:83], v122 offset:16384
    ds_read_b128 a[84:87], v122 offset:17408
    v_mfma_f32_32x32x16_bf16 v[224:239], a[20:23], v[48:51], v[224:239]
    buffer_load_dwordx4 v16, s[36:39], s60 offen offset:2048 lds
    ds_read_b64_tr_b16 a[132:133], v24 offset:28672
    ds_read_b64_tr_b16 a[134:135], v24 offset:29184
    ds_read_b128 a[88:91], v122 offset:18432
    ds_read_b128 a[92:95], v122 offset:19456
    v_mfma_f32_32x32x16_bf16 v[240:255], a[20:23], v[52:55], v[240:255]
    buffer_load_dwordx4 v17, s[36:39], s60 offen offset:3072 lds
    ds_read_b64_tr_b16 a[136:137], v23 offset:30720
    ds_read_b64_tr_b16 a[138:139], v23 offset:31232
    ds_read_b128 a[96:99], v123 offset:8192
    ds_read_b128 a[100:103], v123 offset:9216
    v_mfma_f32_32x32x16_bf16 v[224:239], a[28:31], v[56:59], v[224:239]
    s_add_u32 m0, s53, 0
    s_add_u32 s60, s95, 28672
    buffer_load_dwordx4 v14, s[36:39], s60 offen lds
    ds_read_b64_tr_b16 a[140:141], v24 offset:30720
    ds_read_b64_tr_b16 a[142:143], v24 offset:31232
    ds_read_b128 a[104:107], v123 offset:10240
    ds_read_b128 a[108:111], v123 offset:11264
    v_mfma_f32_32x32x16_bf16 v[240:255], a[28:31], v[60:63], v[240:255]
    s_waitcnt lgkmcnt(14)
    buffer_load_dwordx4 v15, s[36:39], s60 offen offset:1024 lds
    ds_read_b128 a[112:115], v123 offset:16384
    ds_read_b128 a[116:119], v123 offset:17408
    v_mfma_f32_32x32x16_bf16 v[192:207], a[224:227], a[32:35], v[192:207]
    buffer_load_dwordx4 v16, s[36:39], s60 offen offset:2048 lds
    ds_read_b128 a[120:123], v123 offset:18432
    ds_read_b128 a[124:127], v123 offset:19456
    v_mfma_f32_32x32x16_bf16 v[208:223], a[224:227], a[36:39], v[208:223]
    buffer_load_dwordx4 v17, s[36:39], s60 offen offset:3072 lds
    ds_read_b32 v96, v108 offset:20480
    ds_read_b32 v97, v108 offset:20608
    v_mfma_f32_32x32x16_bf16 v[192:207], a[232:235], a[40:43], v[192:207]
    ds_read_b32 v98, v109 offset:20480
    ds_read_b32 v99, v109 offset:20608
    v_mfma_f32_32x32x16_bf16 v[208:223], a[232:235], a[44:47], v[208:223]
    ds_read_b32 v100, v110 offset:20480
    ds_read_b32 v101, v110 offset:20608
    v_mfma_f32_32x32x16_bf16 v[224:239], a[228:231], a[32:35], v[224:239]
    s_waitcnt lgkmcnt(12)
    s_add_u32 m0, s53, 4096
    s_add_u32 s60, s96, 0
    buffer_load_dwordx4 v14, s[36:39], s60 offen lds
    ds_read_b32 v102, v111 offset:20480
    ds_read_b32 v103, v111 offset:20608
    v_mfma_f32_32x32x16_bf16 v[240:255], a[228:231], a[36:39], v[240:255]
    buffer_load_dwordx4 v15, s[36:39], s60 offen offset:1024 lds
    s_waitcnt lgkmcnt(5)
    v_add_f32 v114, v96, v98
    s_waitcnt lgkmcnt(1)
    v_add_f32 v100, v100, v102
    v_mfma_f32_32x32x16_bf16 v[224:239], a[236:239], a[40:43], v[224:239]
    buffer_load_dwordx4 v16, s[36:39], s60 offen offset:2048 lds
    v_add_f32 v114, v114, v100
    v_rcp_f32 v114, v114
    v_mfma_f32_32x32x16_bf16 v[240:255], a[236:239], a[44:47], v[240:255]
    buffer_load_dwordx4 v17, s[36:39], s60 offen offset:3072 lds
    s_waitcnt vmcnt(12)
    ds_read_b64_tr_b16 a[144:145], v23 offset:12288
    ds_read_b64_tr_b16 a[146:147], v23 offset:12800
    v_add_f32 v115, v97, v99
    s_waitcnt lgkmcnt(2)
    v_add_f32 v101, v101, v103
    v_mfma_f32_32x32x16_bf16 v[192:207], a[240:243], a[48:51], v[192:207]
    s_add_u32 m0, s53, 36864
    s_add_u32 s60, s96, 28672
    buffer_load_dwordx4 v14, s[36:39], s60 offen lds
    ds_read_b64_tr_b16 a[148:149], v24 offset:12288
    ds_read_b64_tr_b16 a[150:151], v24 offset:12800
    v_add_f32 v115, v115, v101
    v_rcp_f32 v115, v115
    v_mfma_f32_32x32x16_bf16 v[208:223], a[240:243], a[52:55], v[208:223]
    buffer_load_dwordx4 v15, s[36:39], s60 offen offset:1024 lds
    ds_read_b64_tr_b16 a[152:153], v23 offset:14336
    ds_read_b64_tr_b16 a[154:155], v23 offset:14848
    v_mfma_f32_32x32x16_bf16 v[192:207], a[248:251], a[56:59], v[192:207]
    buffer_load_dwordx4 v16, s[36:39], s60 offen offset:2048 lds
    ds_read_b64_tr_b16 a[156:157], v24 offset:14336
    ds_read_b64_tr_b16 a[158:159], v24 offset:14848
    v_mfma_f32_32x32x16_bf16 v[208:223], a[248:251], a[60:63], v[208:223]
    buffer_load_dwordx4 v17, s[36:39], s60 offen offset:3072 lds
    s_waitcnt vmcnt(12)
    ds_read_b64_tr_b16 a[160:161], v23 offset:32768
    ds_read_b64_tr_b16 a[162:163], v23 offset:33280
    v_mfma_f32_32x32x16_bf16 v[224:239], a[244:247], a[48:51], v[224:239]
    ds_read_b64_tr_b16 a[164:165], v24 offset:32768
    ds_read_b64_tr_b16 a[166:167], v24 offset:33280
    v_mfma_f32_32x32x16_bf16 v[240:255], a[244:247], a[52:55], v[240:255]
    s_add_u32 m0, s53, 24576
    s_add_u32 s60, s97, 0
    buffer_load_dwordx4 v14, s[36:39], s60 offen lds
    ds_read_b64_tr_b16 a[168:169], v23 offset:34816
    ds_read_b64_tr_b16 a[170:171], v23 offset:35328
    v_mfma_f32_32x32x16_bf16 v[224:239], a[252:255], a[56:59], v[224:239]
    buffer_load_dwordx4 v15, s[36:39], s60 offen offset:1024 lds
    ds_read_b64_tr_b16 a[172:173], v24 offset:34816
    ds_read_b64_tr_b16 a[174:175], v24 offset:35328
    v_mfma_f32_32x32x16_bf16 v[240:255], a[252:255], a[60:63], v[240:255]
    buffer_load_dwordx4 v16, s[36:39], s60 offen offset:2048 lds
    v_mfma_f32_32x32x16_bf16 v[192:207], a[128:131], a[64:67], v[192:207]
    s_waitcnt lgkmcnt(8)
    buffer_load_dwordx4 v17, s[36:39], s60 offen offset:3072 lds
    s_waitcnt vmcnt(12)
    ds_read_b64_tr_b16 a[176:177], v23 offset:0
    ds_read_b64_tr_b16 a[178:179], v23 offset:512
    v_mfma_f32_32x32x16_bf16 v[208:223], a[128:131], a[68:71], v[208:223]
    ds_read_b64_tr_b16 a[180:181], v24 offset:0
    ds_read_b64_tr_b16 a[182:183], v24 offset:512
    v_mfma_f32_32x32x16_bf16 v[192:207], a[136:139], a[72:75], v[192:207]
    s_add_u32 m0, s53, 28672
    s_add_u32 s60, s97, 28672
    buffer_load_dwordx4 v14, s[36:39], s60 offen lds
    ds_read_b64_tr_b16 a[184:185], v23 offset:2048
    ds_read_b64_tr_b16 a[186:187], v23 offset:2560
    v_mfma_f32_32x32x16_bf16 v[208:223], a[136:139], a[76:79], v[208:223]
    buffer_load_dwordx4 v15, s[36:39], s60 offen offset:1024 lds
    ds_read_b64_tr_b16 a[188:189], v24 offset:2048
    ds_read_b64_tr_b16 a[190:191], v24 offset:2560
    v_mfma_f32_32x32x16_bf16 v[224:239], a[132:135], a[64:67], v[224:239]
    s_waitcnt lgkmcnt(8)
    v_mfma_f32_32x32x16_bf16 v[240:255], a[132:135], a[68:71], v[240:255]
    buffer_load_dwordx4 v16, s[36:39], s60 offen offset:2048 lds
    s_waitcnt vmcnt(11)
    ds_read_b64_tr_b16 a[192:193], v23 offset:4096
    ds_read_b64_tr_b16 a[194:195], v23 offset:4608
    v_mfma_f32_32x32x16_bf16 v[224:239], a[140:143], a[72:75], v[224:239]
    buffer_load_dwordx4 v17, s[36:39], s60 offen offset:3072 lds
    ds_read_b64_tr_b16 a[196:197], v24 offset:4096
    ds_read_b64_tr_b16 a[198:199], v24 offset:4608
    v_mfma_f32_32x32x16_bf16 v[240:255], a[140:143], a[76:79], v[240:255]
    s_add_u32 m0, s53, 12288
    s_add_u32 s60, s98, 0
    buffer_load_dwordx4 v14, s[36:39], s60 offen lds
    ds_read_b64_tr_b16 a[200:201], v23 offset:6144
    ds_read_b64_tr_b16 a[202:203], v23 offset:6656
    v_mfma_f32_32x32x16_bf16 v[192:207], a[144:147], a[80:83], v[192:207]
    buffer_load_dwordx4 v15, s[36:39], s60 offen offset:1024 lds
    ds_read_b64_tr_b16 a[204:205], v24 offset:6144
    ds_read_b64_tr_b16 a[206:207], v24 offset:6656
    v_mfma_f32_32x32x16_bf16 v[208:223], a[144:147], a[84:87], v[208:223]
    s_waitcnt lgkmcnt(8)
    buffer_load_dwordx4 v16, s[36:39], s60 offen offset:2048 lds
    v_mfma_f32_32x32x16_bf16 v[192:207], a[152:155], a[88:91], v[192:207]
    v_mfma_f32_32x32x16_bf16 v[208:223], a[152:155], a[92:95], v[208:223]
    buffer_load_dwordx4 v17, s[36:39], s60 offen offset:3072 lds
    s_waitcnt vmcnt(12)
    ds_read_b64_tr_b16 a[208:209], v23 offset:36864
    ds_read_b64_tr_b16 a[210:211], v23 offset:37376
    v_mfma_f32_32x32x16_bf16 v[224:239], a[148:151], a[80:83], v[224:239]
    s_add_u32 m0, s53, 32768
    s_add_u32 s60, s98, 28672
    buffer_load_dwordx4 v14, s[36:39], s60 offen lds
    ds_read_b64_tr_b16 a[212:213], v24 offset:36864
    ds_read_b64_tr_b16 a[214:215], v24 offset:37376
    v_mfma_f32_32x32x16_bf16 v[240:255], a[148:151], a[84:87], v[240:255]
    buffer_load_dwordx4 v15, s[36:39], s60 offen offset:1024 lds
    ds_read_b64_tr_b16 a[216:217], v23 offset:38912
    ds_read_b64_tr_b16 a[218:219], v23 offset:39424
    v_mfma_f32_32x32x16_bf16 v[224:239], a[156:159], a[88:91], v[224:239]
    s_waitcnt lgkmcnt(6)
    buffer_load_dwordx4 v16, s[36:39], s60 offen offset:2048 lds
    ds_read_b64_tr_b16 a[220:221], v24 offset:38912
    ds_read_b64_tr_b16 a[222:223], v24 offset:39424
    v_mfma_f32_32x32x16_bf16 v[240:255], a[156:159], a[92:95], v[240:255]
    v_mfma_f32_32x32x16_bf16 v[192:207], a[160:163], a[96:99], v[192:207]
    buffer_load_dwordx4 v17, s[36:39], s60 offen offset:3072 lds
    s_waitcnt vmcnt(12)
    ds_read_b64_tr_b16 a[0:1], v23 offset:24576
    ds_read_b64_tr_b16 a[2:3], v23 offset:25088
    v_mfma_f32_32x32x16_bf16 v[208:223], a[160:163], a[100:103], v[208:223]
    s_add_u32 m0, s53, 0
    s_add_u32 s60, s99, 0
    buffer_load_dwordx4 v14, s[36:39], s60 offen lds
    ds_read_b64_tr_b16 a[4:5], v24 offset:24576
    ds_read_b64_tr_b16 a[6:7], v24 offset:25088
    v_mfma_f32_32x32x16_bf16 v[192:207], a[168:171], a[104:107], v[192:207]
    buffer_load_dwordx4 v15, s[36:39], s60 offen offset:1024 lds
    ds_read_b64_tr_b16 a[8:9], v23 offset:26624
    ds_read_b64_tr_b16 a[10:11], v23 offset:27136
    v_mfma_f32_32x32x16_bf16 v[208:223], a[168:171], a[108:111], v[208:223]
    ds_read_b64_tr_b16 a[12:13], v24 offset:26624
    ds_read_b64_tr_b16 a[14:15], v24 offset:27136
    v_mfma_f32_32x32x16_bf16 v[224:239], a[164:167], a[96:99], v[224:239]
    s_waitcnt lgkmcnt(8)
    buffer_load_dwordx4 v16, s[36:39], s60 offen offset:2048 lds
    s_waitcnt vmcnt(11)
    ds_read_b64_tr_b16 a[16:17], v23 offset:28672
    ds_read_b64_tr_b16 a[18:19], v23 offset:29184
    v_mfma_f32_32x32x16_bf16 v[240:255], a[164:167], a[100:103], v[240:255]
    buffer_load_dwordx4 v17, s[36:39], s60 offen offset:3072 lds
    ds_read_b64_tr_b16 a[20:21], v24 offset:28672
    ds_read_b64_tr_b16 a[22:23], v24 offset:29184
    v_mfma_f32_32x32x16_bf16 v[224:239], a[172:175], a[104:107], v[224:239]
    s_add_u32 m0, s53, 4096
    s_add_u32 s60, s99, 28672
    buffer_load_dwordx4 v14, s[36:39], s60 offen lds
    ds_read_b64_tr_b16 a[24:25], v23 offset:30720
    ds_read_b64_tr_b16 a[26:27], v23 offset:31232
    v_mfma_f32_32x32x16_bf16 v[240:255], a[172:175], a[108:111], v[240:255]
    buffer_load_dwordx4 v15, s[36:39], s60 offen offset:1024 lds
    ds_read_b64_tr_b16 a[28:29], v24 offset:30720
    ds_read_b64_tr_b16 a[30:31], v24 offset:31232
    v_mfma_f32_32x32x16_bf16 v[192:207], a[176:179], a[112:115], v[192:207]
    buffer_load_dwordx4 v16, s[36:39], s60 offen offset:2048 lds
    v_mfma_f32_32x32x16_bf16 v[208:223], a[176:179], a[116:119], v[208:223]
    s_waitcnt lgkmcnt(8)
    v_mfma_f32_32x32x16_bf16 v[192:207], a[184:187], a[120:123], v[192:207]
    buffer_load_dwordx4 v17, s[36:39], s60 offen offset:3072 lds
    s_lshl_b32 s60, s45, 2
    buffer_load_dword v125, v124, s[4:7], s60 offen offset:128 sc1
    s_waitcnt vmcnt(13)
    ds_read_b64_tr_b16 a[224:225], v23 offset:12288
    ds_read_b64_tr_b16 a[226:227], v23 offset:12800
    v_mfma_f32_32x32x16_bf16 v[208:223], a[184:187], a[124:127], v[208:223]
    ds_read_b64_tr_b16 a[228:229], v24 offset:12288
    ds_read_b64_tr_b16 a[230:231], v24 offset:12800
    v_mfma_f32_32x32x16_bf16 v[224:239], a[180:183], a[112:115], v[224:239]
    ds_read_b64_tr_b16 a[232:233], v23 offset:14336
    ds_read_b64_tr_b16 a[234:235], v23 offset:14848
    ds_read_b64_tr_b16 a[236:237], v24 offset:14336
    ds_read_b64_tr_b16 a[238:239], v24 offset:14848
    v_mfma_f32_32x32x16_bf16 v[240:255], a[180:183], a[116:119], v[240:255]
    s_waitcnt lgkmcnt(8)
    v_mfma_f32_32x32x16_bf16 v[224:239], a[188:191], a[120:123], v[224:239]
    s_waitcnt vmcnt(9)
    ds_read_b64_tr_b16 a[240:241], v23 offset:32768
    ds_read_b64_tr_b16 a[242:243], v23 offset:33280
    v_mfma_f32_32x32x16_bf16 v[240:255], a[188:191], a[124:127], v[240:255]
    ds_read_b64_tr_b16 a[244:245], v24 offset:32768
    ds_read_b64_tr_b16 a[246:247], v24 offset:33280
    v_mfma_f32_32x32x16_bf16 v[128:143], a[192:195], v[32:35], 0
    ds_read_b64_tr_b16 a[248:249], v23 offset:34816
    ds_read_b64_tr_b16 a[250:251], v23 offset:35328
    v_mfma_f32_32x32x16_bf16 v[144:159], a[192:195], v[36:39], 0
    ds_read_b64_tr_b16 a[252:253], v24 offset:34816
    ds_read_b64_tr_b16 a[254:255], v24 offset:35328
    v_mfma_f32_32x32x16_bf16 v[128:143], a[200:203], v[40:43], v[128:143]
    s_waitcnt lgkmcnt(8)
    v_mul_f32 v192, v192, v114
    v_mul_f32 v193, v193, v114
    v_mul_f32 v194, v194, v114
    v_mul_f32 v195, v195, v114
    v_mfma_f32_32x32x16_bf16 v[144:159], a[200:203], v[44:47], v[144:159]
    v_mul_f32 v196, v196, v114
    v_mul_f32 v197, v197, v114
    v_mul_f32 v198, v198, v114
    v_mul_f32 v199, v199, v114
    v_mfma_f32_32x32x16_bf16 v[128:143], a[208:211], v[48:51], v[128:143]
    s_waitcnt vmcnt(5)
    ds_read_b64_tr_b16 a[128:129], v23 offset:0
    ds_read_b64_tr_b16 a[130:131], v23 offset:512
    v_cvt_pk_bf16_f32 v64, v192, v193
    v_cvt_pk_bf16_f32 v65, v194, v195
    v_cvt_pk_bf16_f32 v66, v196, v197
    v_cvt_pk_bf16_f32 v67, v198, v199
    v_mfma_f32_32x32x16_bf16 v[144:159], a[208:211], v[52:55], v[144:159]
    ds_read_b64_tr_b16 a[132:133], v24 offset:0
    ds_read_b64_tr_b16 a[134:135], v24 offset:512
    s_add_u32 s55, s56, 0
    buffer_store_dwordx4 v[64:67], v28, s[40:43], s55 offen sc1
    v_mul_f32 v200, v200, v114
    v_mul_f32 v201, v201, v114
    v_mfma_f32_32x32x16_bf16 v[128:143], a[216:219], v[56:59], v[128:143]
    s_waitcnt lgkmcnt(4)
    ds_read_b64_tr_b16 a[136:137], v23 offset:2048
    ds_read_b64_tr_b16 a[138:139], v23 offset:2560
    v_mul_f32 v202, v202, v114
    v_mul_f32 v203, v203, v114
    v_mul_f32 v204, v204, v114
    v_mul_f32 v205, v205, v114
    v_mfma_f32_32x32x16_bf16 v[144:159], a[216:219], v[60:63], v[144:159]
    ds_read_b64_tr_b16 a[140:141], v24 offset:2048
    ds_read_b64_tr_b16 a[142:143], v24 offset:2560
    v_mul_f32 v206, v206, v114
    v_mul_f32 v207, v207, v114
    v_cvt_pk_bf16_f32 v68, v200, v201
    v_cvt_pk_bf16_f32 v69, v202, v203
    v_mfma_f32_32x32x16_bf16 v[128:143], a[0:3], a[32:35], v[128:143]
    s_waitcnt vmcnt(2)
    ds_read_b64_tr_b16 a[144:145], v23 offset:4096
    ds_read_b64_tr_b16 a[146:147], v23 offset:4608
    v_cvt_pk_bf16_f32 v70, v204, v205
    v_cvt_pk_bf16_f32 v71, v206, v207
    s_add_u32 s55, s56, 16384
    buffer_store_dwordx4 v[68:71], v28, s[40:43], s55 offen sc1
    v_mfma_f32_32x32x16_bf16 v[144:159], a[0:3], a[36:39], v[144:159]
    ds_read_b64_tr_b16 a[148:149], v24 offset:4096
    ds_read_b64_tr_b16 a[150:151], v24 offset:4608
    v_mul_f32 v208, v208, v115
    v_mul_f32 v209, v209, v115
    v_mul_f32 v210, v210, v115
    v_mul_f32 v211, v211, v115
    v_mfma_f32_32x32x16_bf16 v[128:143], a[8:11], a[40:43], v[128:143]
    ds_read_b64_tr_b16 a[152:153], v23 offset:6144
    ds_read_b64_tr_b16 a[154:155], v23 offset:6656
    v_mul_f32 v212, v212, v115
    v_mul_f32 v213, v213, v115
    v_mul_f32 v214, v214, v115
    v_mul_f32 v215, v215, v115
    v_mfma_f32_32x32x16_bf16 v[144:159], a[8:11], a[44:47], v[144:159]
    ds_read_b64_tr_b16 a[156:157], v24 offset:6144
    ds_read_b64_tr_b16 a[158:159], v24 offset:6656
    v_cvt_pk_bf16_f32 v72, v208, v209
    v_cvt_pk_bf16_f32 v73, v210, v211
    v_cvt_pk_bf16_f32 v74, v212, v213
    v_cvt_pk_bf16_f32 v75, v214, v215
    v_mfma_f32_32x32x16_bf16 v[128:143], a[16:19], a[48:51], v[128:143]
    s_waitcnt lgkmcnt(8)
    s_add_u32 s55, s56, 32768
    buffer_store_dwordx4 v[72:75], v28, s[40:43], s55 offen sc1
    v_mul_f32 v216, v216, v115
    v_mul_f32 v217, v217, v115
    v_mfma_f32_32x32x16_bf16 v[144:159], a[16:19], a[52:55], v[144:159]
    v_mul_f32 v218, v218, v115
    v_mul_f32 v219, v219, v115
    v_mul_f32 v220, v220, v115
    v_mul_f32 v221, v221, v115
    v_mfma_f32_32x32x16_bf16 v[128:143], a[24:27], a[56:59], v[128:143]
    v_mul_f32 v222, v222, v115
    v_mul_f32 v223, v223, v115
    v_cvt_pk_bf16_f32 v76, v216, v217
    v_cvt_pk_bf16_f32 v77, v218, v219
    v_mfma_f32_32x32x16_bf16 v[144:159], a[24:27], a[60:63], v[144:159]
    v_cvt_pk_bf16_f32 v78, v220, v221
    v_cvt_pk_bf16_f32 v79, v222, v223
    s_add_u32 s55, s56, 49152
    buffer_store_dwordx4 v[76:79], v28, s[40:43], s55 offen sc1
    v_mfma_f32_32x32x16_bf16 v[128:143], a[224:227], a[64:67], v[128:143]
    s_waitcnt lgkmcnt(0)
    v_mul_f32 v224, v224, v114
    v_mul_f32 v225, v225, v114
    v_mul_f32 v226, v226, v114
    v_mul_f32 v227, v227, v114
    v_mfma_f32_32x32x16_bf16 v[144:159], a[224:227], a[68:71], v[144:159]
    v_mul_f32 v228, v228, v114
    v_mul_f32 v229, v229, v114
    v_mul_f32 v230, v230, v114
    v_mul_f32 v231, v231, v114
    v_mfma_f32_32x32x16_bf16 v[128:143], a[232:235], a[72:75], v[128:143]
    v_cvt_pk_bf16_f32 v80, v224, v225
    v_cvt_pk_bf16_f32 v81, v226, v227
    v_cvt_pk_bf16_f32 v82, v228, v229
    v_cvt_pk_bf16_f32 v83, v230, v231
    v_mfma_f32_32x32x16_bf16 v[144:159], a[232:235], a[76:79], v[144:159]
    s_add_u32 s55, s56, 65536
    buffer_store_dwordx4 v[80:83], v28, s[40:43], s55 offen sc1
    v_mul_f32 v232, v232, v114
    v_mul_f32 v233, v233, v114
    v_mfma_f32_32x32x16_bf16 v[128:143], a[240:243], a[80:83], v[128:143]
    v_mul_f32 v234, v234, v114
    v_mul_f32 v235, v235, v114
    v_mul_f32 v236, v236, v114
    v_mul_f32 v237, v237, v114
    v_mfma_f32_32x32x16_bf16 v[144:159], a[240:243], a[84:87], v[144:159]
    v_mul_f32 v238, v238, v114
    v_mul_f32 v239, v239, v114
    v_cvt_pk_bf16_f32 v84, v232, v233
    v_cvt_pk_bf16_f32 v85, v234, v235
    v_mfma_f32_32x32x16_bf16 v[128:143], a[248:251], a[88:91], v[128:143]
    v_cvt_pk_bf16_f32 v86, v236, v237
    v_cvt_pk_bf16_f32 v87, v238, v239
    s_add_u32 s55, s56, 81920
    buffer_store_dwordx4 v[84:87], v28, s[40:43], s55 offen sc1
    v_mfma_f32_32x32x16_bf16 v[144:159], a[248:251], a[92:95], v[144:159]
    v_mul_f32 v240, v240, v115
    v_mul_f32 v241, v241, v115
    v_mul_f32 v242, v242, v115
    v_mul_f32 v243, v243, v115
    v_mfma_f32_32x32x16_bf16 v[128:143], a[128:131], a[96:99], v[128:143]
    v_mul_f32 v244, v244, v115
    v_mul_f32 v245, v245, v115
    v_mul_f32 v246, v246, v115
    v_mul_f32 v247, v247, v115
    v_mfma_f32_32x32x16_bf16 v[144:159], a[128:131], a[100:103], v[144:159]
    v_cvt_pk_bf16_f32 v88, v240, v241
    v_cvt_pk_bf16_f32 v89, v242, v243
    v_cvt_pk_bf16_f32 v90, v244, v245
    v_cvt_pk_bf16_f32 v91, v246, v247
    v_mfma_f32_32x32x16_bf16 v[128:143], a[136:139], a[104:107], v[128:143]
    s_add_u32 s55, s56, 98304
    buffer_store_dwordx4 v[88:91], v28, s[40:43], s55 offen sc1
    v_mul_f32 v248, v248, v115
    v_mul_f32 v249, v249, v115
    v_mfma_f32_32x32x16_bf16 v[144:159], a[136:139], a[108:111], v[144:159]
    v_mul_f32 v250, v250, v115
    v_mul_f32 v251, v251, v115
    v_mul_f32 v252, v252, v115
    v_mul_f32 v253, v253, v115
    v_mfma_f32_32x32x16_bf16 v[128:143], a[144:147], a[112:115], v[128:143]
    v_mul_f32 v254, v254, v115
    v_mul_f32 v255, v255, v115
    v_cvt_pk_bf16_f32 v92, v248, v249
    v_cvt_pk_bf16_f32 v93, v250, v251
    v_mfma_f32_32x32x16_bf16 v[144:159], a[144:147], a[116:119], v[144:159]
    v_cvt_pk_bf16_f32 v94, v252, v253
    v_cvt_pk_bf16_f32 v95, v254, v255
    s_add_u32 s55, s56, 114688
    buffer_store_dwordx4 v[92:95], v28, s[40:43], s55 offen sc1
    s_lshr_b32 s24, s46, 1
    s_and_b32 s25, s46, 1
    s_lshr_b32 s26, s44, 1
    v_mfma_f32_32x32x16_bf16 v[128:143], a[152:155], a[120:123], v[128:143]
    s_and_b32 s27, s44, 1
    s_lshl_b32 s34, s24, 1
    s_add_u32 s34, s34, s26
    v_mfma_f32_32x32x16_bf16 v[144:159], a[152:155], a[124:127], v[144:159]
    s_lshl_b32 s34, s34, 1
    s_add_u32 s34, s34, s25
    s_lshl_b32 s34, s34, 1
    v_mfma_f32_32x32x16_bf16 v[160:175], a[196:199], v[32:35], 0
    v_mfma_f32_32x32x16_bf16 v[176:191], a[196:199], v[36:39], 0
    v_mfma_f32_32x32x16_bf16 v[160:175], a[204:207], v[40:43], v[160:175]
    s_nop 1
    v_mul_f32 v128, v128, v114
    v_mul_f32 v129, v129, v114
    v_mfma_f32_32x32x16_bf16 v[176:191], a[204:207], v[44:47], v[176:191]
    v_mul_f32 v130, v130, v114
    v_mul_f32 v131, v131, v114
    v_mfma_f32_32x32x16_bf16 v[160:175], a[212:215], v[48:51], v[160:175]
    v_mul_f32 v132, v132, v114
    v_mul_f32 v133, v133, v114
    v_mfma_f32_32x32x16_bf16 v[176:191], a[212:215], v[52:55], v[176:191]
    v_mul_f32 v134, v134, v114
    v_mul_f32 v135, v135, v114
    v_mfma_f32_32x32x16_bf16 v[160:175], a[220:223], v[56:59], v[160:175]
    v_cvt_pk_bf16_f32 v64, v128, v129
    v_cvt_pk_bf16_f32 v65, v130, v131
    v_mfma_f32_32x32x16_bf16 v[176:191], a[220:223], v[60:63], v[176:191]
    v_cvt_pk_bf16_f32 v66, v132, v133
    v_cvt_pk_bf16_f32 v67, v134, v135
    v_mfma_f32_32x32x16_bf16 v[160:175], a[4:7], a[32:35], v[160:175]
    s_add_u32 s55, s57, 0
    buffer_store_dwordx4 v[64:67], v28, s[40:43], s55 offen sc1
    v_mfma_f32_32x32x16_bf16 v[176:191], a[4:7], a[36:39], v[176:191]
    v_mul_f32 v136, v136, v114
    v_mul_f32 v137, v137, v114
    v_mfma_f32_32x32x16_bf16 v[160:175], a[12:15], a[40:43], v[160:175]
    v_mul_f32 v138, v138, v114
    v_mul_f32 v139, v139, v114
    v_mfma_f32_32x32x16_bf16 v[176:191], a[12:15], a[44:47], v[176:191]
    v_mul_f32 v140, v140, v114
    v_mul_f32 v141, v141, v114
    v_mfma_f32_32x32x16_bf16 v[160:175], a[20:23], a[48:51], v[160:175]
    v_mul_f32 v142, v142, v114
    v_mul_f32 v143, v143, v114
    v_mfma_f32_32x32x16_bf16 v[176:191], a[20:23], a[52:55], v[176:191]
    v_cvt_pk_bf16_f32 v68, v136, v137
    v_cvt_pk_bf16_f32 v69, v138, v139
    v_mfma_f32_32x32x16_bf16 v[160:175], a[28:31], a[56:59], v[160:175]
    v_cvt_pk_bf16_f32 v70, v140, v141
    v_cvt_pk_bf16_f32 v71, v142, v143
    v_mfma_f32_32x32x16_bf16 v[176:191], a[28:31], a[60:63], v[176:191]
    s_add_u32 s55, s57, 16384
    buffer_store_dwordx4 v[68:71], v28, s[40:43], s55 offen sc1
    v_mfma_f32_32x32x16_bf16 v[160:175], a[228:231], a[64:67], v[160:175]
    v_mul_f32 v144, v144, v115
    v_mul_f32 v145, v145, v115
    v_mfma_f32_32x32x16_bf16 v[176:191], a[228:231], a[68:71], v[176:191]
    v_mul_f32 v146, v146, v115
    v_mul_f32 v147, v147, v115
    v_mfma_f32_32x32x16_bf16 v[160:175], a[236:239], a[72:75], v[160:175]
    v_mul_f32 v148, v148, v115
    v_mul_f32 v149, v149, v115
    v_mfma_f32_32x32x16_bf16 v[176:191], a[236:239], a[76:79], v[176:191]
    v_mul_f32 v150, v150, v115
    v_mul_f32 v151, v151, v115
    v_mfma_f32_32x32x16_bf16 v[160:175], a[244:247], a[80:83], v[160:175]
    v_cvt_pk_bf16_f32 v72, v144, v145
    v_cvt_pk_bf16_f32 v73, v146, v147
    v_mfma_f32_32x32x16_bf16 v[176:191], a[244:247], a[84:87], v[176:191]
    v_cvt_pk_bf16_f32 v74, v148, v149
    v_cvt_pk_bf16_f32 v75, v150, v151
    v_mfma_f32_32x32x16_bf16 v[160:175], a[252:255], a[88:91], v[160:175]
    s_add_u32 s55, s57, 32768
    buffer_store_dwordx4 v[72:75], v28, s[40:43], s55 offen sc1
    v_mfma_f32_32x32x16_bf16 v[176:191], a[252:255], a[92:95], v[176:191]
    v_mul_f32 v152, v152, v115
    v_mul_f32 v153, v153, v115
    v_mfma_f32_32x32x16_bf16 v[160:175], a[132:135], a[96:99], v[160:175]
    v_mul_f32 v154, v154, v115
    v_mul_f32 v155, v155, v115
    v_mfma_f32_32x32x16_bf16 v[176:191], a[132:135], a[100:103], v[176:191]
    v_mul_f32 v156, v156, v115
    v_mul_f32 v157, v157, v115
    v_mfma_f32_32x32x16_bf16 v[160:175], a[140:143], a[104:107], v[160:175]
    v_mul_f32 v158, v158, v115
    v_mul_f32 v159, v159, v115
    v_mfma_f32_32x32x16_bf16 v[176:191], a[140:143], a[108:111], v[176:191]
    v_cvt_pk_bf16_f32 v76, v152, v153
    v_cvt_pk_bf16_f32 v77, v154, v155
    v_mfma_f32_32x32x16_bf16 v[160:175], a[148:151], a[112:115], v[160:175]
    v_cvt_pk_bf16_f32 v78, v156, v157
    v_cvt_pk_bf16_f32 v79, v158, v159
    v_mfma_f32_32x32x16_bf16 v[176:191], a[148:151], a[116:119], v[176:191]
    s_add_u32 s55, s57, 49152
    buffer_store_dwordx4 v[76:79], v28, s[40:43], s55 offen sc1
    s_add_u32 s34, s34, s27
    s_add_u32 s34, s34, 1
    s_lshl_b32 s34, s34, 14
    v_mfma_f32_32x32x16_bf16 v[160:175], a[156:159], a[120:123], v[160:175]
    s_mul_i32 s28, s45, 966656
    s_add_u32 s34, s34, s28
    s_mul_i32 s35, s25, 28672
    v_mfma_f32_32x32x16_bf16 v[176:191], a[156:159], a[124:127], v[176:191]
    s_add_u32 s35, s35, s12
    s_lshl_b32 s29, s24, 7
    s_add_u32 s35, s35, s29
    s_lshl_b32 s29, s26, 6
    s_add_u32 s35, s35, s29
    s_lshl_b32 s29, s27, 5
    s_add_u32 s35, s35, s29
    v_and_b32 v4, 31, v0
    v_lshrrev_b32 v5, 5, v0
    v_lshlrev_b32 v5, 4, v5
    s_movk_i32 s29, 896
    v_mad_u32_u24 v4, v4, s29, v5
    v_and_b32 v2, 15, v0
    v_lshlrev_b32 v2, 2, v2
    s_add_u32 s28, s28, 933888
    s_lshl_b32 s30, s46, 2
    s_add_u32 s30, s30, s28
    s_lshl_b32 s33, s45, 2
    s_mov_b32 s24, 0x00003f80
    s_mov_b32 s25, 0x3f800000
    s_mov_b32 s32, 0
    v_mul_f32 v160, v160, v114
    v_mul_f32 v161, v161, v114
    v_mul_f32 v162, v162, v114
    v_mul_f32 v163, v163, v114
    v_mul_f32 v164, v164, v114
    v_mul_f32 v165, v165, v114
    v_mul_f32 v166, v166, v114
    v_mul_f32 v167, v167, v114
    v_cvt_pk_bf16_f32 v80, v160, v161
    v_cvt_pk_bf16_f32 v81, v162, v163
    v_cvt_pk_bf16_f32 v82, v164, v165
    v_cvt_pk_bf16_f32 v83, v166, v167
    s_add_u32 s55, s57, 65536
    buffer_store_dwordx4 v[80:83], v28, s[40:43], s55 offen sc1
    v_mul_f32 v168, v168, v114
    v_mul_f32 v169, v169, v114
    v_mul_f32 v170, v170, v114
    v_mul_f32 v171, v171, v114
    v_mul_f32 v172, v172, v114
    v_mul_f32 v173, v173, v114
    v_mul_f32 v174, v174, v114
    v_mul_f32 v175, v175, v114
    v_cvt_pk_bf16_f32 v84, v168, v169
    v_cvt_pk_bf16_f32 v85, v170, v171
    v_cvt_pk_bf16_f32 v86, v172, v173
    v_cvt_pk_bf16_f32 v87, v174, v175
    s_add_u32 s55, s57, 81920
    buffer_store_dwordx4 v[84:87], v28, s[40:43], s55 offen sc1
    v_mul_f32 v176, v176, v115
    v_mul_f32 v177, v177, v115
    v_mul_f32 v178, v178, v115
    v_mul_f32 v179, v179, v115
    v_mul_f32 v180, v180, v115
    v_mul_f32 v181, v181, v115
    v_mul_f32 v182, v182, v115
    v_mul_f32 v183, v183, v115
    v_cvt_pk_bf16_f32 v88, v176, v177
    v_cvt_pk_bf16_f32 v89, v178, v179
    v_cvt_pk_bf16_f32 v90, v180, v181
    v_cvt_pk_bf16_f32 v91, v182, v183
    s_add_u32 s55, s57, 98304
    buffer_store_dwordx4 v[88:91], v28, s[40:43], s55 offen sc1
    v_mul_f32 v184, v184, v115
    v_mul_f32 v185, v185, v115
    v_mul_f32 v186, v186, v115
    v_mul_f32 v187, v187, v115
    v_mul_f32 v188, v188, v115
    v_mul_f32 v189, v189, v115
    v_mul_f32 v190, v190, v115
    v_mul_f32 v191, v191, v115
    v_cvt_pk_bf16_f32 v92, v184, v185
    v_cvt_pk_bf16_f32 v93, v186, v187
    v_cvt_pk_bf16_f32 v94, v188, v189
    v_cvt_pk_bf16_f32 v95, v190, v191
    s_add_u32 s55, s57, 114688
    buffer_store_dwordx4 v[92:95], v28, s[40:43], s55 offen sc1
    s_branch L_fused_reduce
    L_type1:
    s_mov_b32 s54, 512
    v_mad_u32_u24 v6, v32, s54, v34
    s_add_u32 m0, s3, 0
    s_add_u32 s60, s62, 0
    buffer_load_dwordx4 v18, s[20:23], s60 offen lds
    s_mov_b32 s54, 896
    v_mad_u32_u24 v14, v32, s54, v34
    s_add_u32 m0, s3, 40960
    s_add_u32 s60, s62, 128
    buffer_load_dwordx4 v18, s[20:23], s60 offen lds
    s_mov_b32 s54, 512
    v_mad_u32_u24 v7, v32, s54, v34
    s_add_u32 m0, s3, 81920
    s_add_u32 s60, s62, 256
    buffer_load_dwordx4 v18, s[20:23], s60 offen lds
    v_add_u32 v7, 3072, v7
    s_mov_b32 s54, 896
    v_mad_u32_u24 v15, v32, s54, v34
    v_add_u32 v15, 6144, v15
    s_mov_b32 s54, 512
    v_mad_u32_u24 v8, v32, s54, v34
    v_add_u32 v8, 6144, v8
    s_mov_b32 s54, 896
    v_mad_u32_u24 v16, v32, s54, v34
    v_add_u32 v16, 12288, v16
    s_mov_b32 s54, 512
    v_mad_u32_u24 v9, v32, s54, v34
    v_add_u32 v9, 9216, v9
    s_mov_b32 s54, 896
    v_mad_u32_u24 v17, v32, s54, v34
    v_add_u32 v17, 18432, v17
    v_bfe_u32 v32, v0, 2, 2
    v_bfe_u32 v33, v0, 4, 1
    v_lshlrev_b32 v33, 5, v33
    v_and_b32 v34, 1, v0
    v_lshl_add_u32 v33, v34, 4, v33
    s_add_u32 m0, s3, 122880
    s_add_u32 s60, s62, 384
    buffer_load_dwordx4 v18, s[20:23], s60 offen lds
    v_bfe_u32 v34, v0, 1, 1
    v_lshl_add_u32 v33, v34, 3, v33
    v_bfe_u32 v34, v0, 3, 1
    v_lshl_add_u32 v33, v34, 6, v33
    v_lshl_add_u32 v33, v32, 7, v33
    v_add_u32 v33, s53, v33
    v_lshl_add_u32 v23, v39, 10, v33
    v_xor_b32 v24, 64, v23
    v_lshl_add_u32 v25, v39, 9, v33
    v_xor_b32 v26, 64, v25
    v_lshlrev_b32 v28, 4, v0
    v_add_u32 v29, 65536, v28
    v_add_u32 v30, 131072, v28
    v_add_u32 v27, s53, v28
    v_lshlrev_b32 v31, 2, v0
    v_add_u32 v31, s53, v31
    s_mul_i32 s59, s46, 229376
    s_lshl_b32 s55, s44, 7
    s_add_u32 s57, s59, s55
    s_add_u32 s54, s44, 0
    s_and_b32 s54, s54, 3
    s_mul_i32 s54, s54, 57344
    s_add_u32 s92, s57, s54
    s_add_u32 s96, s92, 512
    s_cmp_eq_u32 s44, 3
    s_cselect_b32 s96, 0x40000000, s96
    s_add_u32 s54, s44, 1
    s_and_b32 s54, s54, 3
    s_mul_i32 s55, s54, 40960
    v_add_u32 v121, s55, v28
    s_add_u32 m0, s3, 8192
    s_add_u32 s60, s62, 512
    buffer_load_dwordx4 v18, s[20:23], s60 offen lds
    s_mul_i32 s54, s54, 57344
    s_add_u32 s93, s57, s54
    s_add_u32 s97, s93, 512
    s_cmp_eq_u32 s44, 3
    s_cselect_b32 s97, 0x40000000, s97
    s_add_u32 s54, s44, 2
    s_and_b32 s54, s54, 3
    s_mul_i32 s55, s54, 40960
    v_add_u32 v122, s55, v28
    s_mul_i32 s54, s54, 57344
    s_add_u32 s94, s57, s54
    s_add_u32 s98, s94, 512
    s_cmp_eq_u32 s44, 3
    s_cselect_b32 s98, 0x40000000, s98
    s_add_u32 s54, s44, 3
    s_and_b32 s54, s54, 3
    s_mul_i32 s55, s54, 40960
    v_add_u32 v123, s55, v28
    s_mul_i32 s54, s54, 57344
    s_add_u32 s95, s57, s54
    s_add_u32 s99, s95, 512
    s_cmp_eq_u32 s44, 3
    s_cselect_b32 s99, 0x40000000, s99
    s_lshr_b32 s54, s45, 1
    s_lshl_b32 s54, s54, 2
    s_add_u32 s54, s54, s44
    s_mul_i32 s54, s54, 7168
    s_add_u32 s59, s59, s54
    s_mul_i32 s56, s45, 966656
    s_lshl_b32 s54, s46, 10
    s_add_u32 s56, s56, s54
    s_add_u32 s56, s56, 16384
    s_lshl_b32 s54, s44, 17
    s_add_u32 s56, s56, s54
    s_add_u32 s57, s56, 524288
    s_cmp_eq_u32 s44, 3
    s_cselect_b32 s57, 0x40000000, s57
    s_mov_b32 s58, 1035512379
    s_mov_b32 s8, s14
    s_and_b32 s9, s15, 65535
    s_mov_b32 s10, 917504
    s_mov_b32 s11, 131072
    s_mul_i32 s12, s45, 57344
    s_add_u32 m0, s3, 49152
    s_add_u32 s60, s62, 640
    buffer_load_dwordx4 v18, s[20:23], s60 offen lds
    s_add_u32 m0, s3, 90112
    s_add_u32 s60, s62, 768
    buffer_load_dwordx4 v18, s[20:23], s60 offen lds
    s_add_u32 m0, s53, 24576
    s_add_u32 s60, s52, 0
    buffer_load_dwordx4 v10, s[32:35], s60 offen lds
    s_waitcnt vmcnt(13)
    ds_read_b128 a[0:3], v19 offset:16384
    ds_read_b128 a[4:7], v20 offset:16384
    ds_read_b128 a[8:11], v21 offset:16384
    ds_read_b128 a[12:15], v22 offset:16384
    buffer_load_dwordx4 v11, s[32:35], s60 offen offset:1024 lds
    buffer_load_dwordx4 v12, s[32:35], s60 offen offset:2048 lds
    s_waitcnt lgkmcnt(0)
    buffer_load_dwordx4 v13, s[32:35], s60 offen offset:3072 lds
    s_add_u32 m0, s53, 28672
    s_add_u32 s60, s52, 262144
    buffer_load_dwordx4 v10, s[32:35], s60 offen lds
    s_waitcnt vmcnt(13)
    ds_read_b128 a[16:19], v19 offset:20480
    ds_read_b128 a[20:23], v20 offset:20480
    ds_read_b128 a[24:27], v21 offset:20480
    ds_read_b128 a[28:31], v22 offset:20480
    buffer_load_dwordx4 v11, s[32:35], s60 offen offset:1024 lds
    buffer_load_dwordx4 v12, s[32:35], s60 offen offset:2048 lds
    buffer_load_dwordx4 v13, s[32:35], s60 offen offset:3072 lds
    s_add_u32 m0, s53, 32768
    s_add_u32 s60, s52, 524288
    buffer_load_dwordx4 v10, s[32:35], s60 offen lds
    buffer_load_dwordx4 v11, s[32:35], s60 offen offset:1024 lds
    s_waitcnt lgkmcnt(0)
    buffer_load_dwordx4 v12, s[32:35], s60 offen offset:2048 lds
    s_waitcnt vmcnt(11)
    s_barrier
    v_lshrrev_b32 v125, v0, v125
    v_and_b32 v125, 1, v125
    v_cmp_eq_u32 vcc, 0, v125
    s_nop 3
    s_and_b32 s100, vcc_lo, 0xffff
    s_or_b32 s100, s100, 65536
    v_mov_b32 v125, s100
    buffer_store_dword v125, v124, s[4:7], s101 offen sc1
    ds_read_b128 v[64:67], v96 offset:0
    buffer_load_dwordx4 v13, s[32:35], s60 offen offset:3072 lds
    ds_read_b128 v[68:71], v96 offset:4096
    s_add_u32 m0, s53, 36864
    s_add_u32 s60, s52, 786432
    buffer_load_dwordx4 v10, s[32:35], s60 offen lds
    s_waitcnt vmcnt(10)
    ds_read_b64_tr_b16 a[32:33], v23 offset:24576
    ds_read_b128 v[72:75], v97 offset:0
    buffer_load_dwordx4 v11, s[32:35], s60 offen offset:1024 lds
    ds_read_b64_tr_b16 a[34:35], v23 offset:25088
    ds_read_b128 v[76:79], v97 offset:4096
    buffer_load_dwordx4 v12, s[32:35], s60 offen offset:2048 lds
    ds_read_b64_tr_b16 a[36:37], v24 offset:24576
    ds_read_b64_tr_b16 a[38:39], v24 offset:25088
    ds_read_b64_tr_b16 a[40:41], v23 offset:26624
    ds_read_b64_tr_b16 a[42:43], v23 offset:27136
    ds_read_b64_tr_b16 a[44:45], v24 offset:26624
    ds_read_b64_tr_b16 a[46:47], v24 offset:27136
    s_waitcnt lgkmcnt(7)
    v_mfma_f32_32x32x16_bf16 v[128:143], a[32:35], v[64:67], 0
    buffer_load_dwordx4 v13, s[32:35], s60 offen offset:3072 lds
    ds_read_b128 v[80:83], v98 offset:0
    v_mfma_f32_32x32x16_bf16 v[144:159], a[32:35], v[68:71], 0
    s_add_u32 m0, s53, 16384
    s_add_u32 s60, s52, 1048576
    buffer_load_dwordx4 v10, s[32:35], s60 offen lds
    ds_read_b128 v[84:87], v98 offset:4096
    s_waitcnt lgkmcnt(6)
    v_mfma_f32_32x32x16_bf16 v[160:175], a[36:39], v[64:67], 0
    buffer_load_dwordx4 v11, s[32:35], s60 offen offset:1024 lds
    ds_read_b128 v[88:91], v99 offset:0
    buffer_load_dwordx4 v12, s[32:35], s60 offen offset:2048 lds
    s_waitcnt vmcnt(12)
    ds_read_b64_tr_b16 a[48:49], v23 offset:28672
    ds_read_b64_tr_b16 a[50:51], v23 offset:29184
    ds_read_b64_tr_b16 a[52:53], v24 offset:28672
    ds_read_b64_tr_b16 a[54:55], v24 offset:29184
    ds_read_b64_tr_b16 a[56:57], v23 offset:30720
    ds_read_b64_tr_b16 a[58:59], v23 offset:31232
    ds_read_b64_tr_b16 a[60:61], v24 offset:30720
    ds_read_b64_tr_b16 a[62:63], v24 offset:31232
    v_mfma_f32_32x32x16_bf16 v[176:191], a[36:39], v[68:71], 0
    buffer_load_dwordx4 v13, s[32:35], s60 offen offset:3072 lds
    ds_read_b128 v[92:95], v99 offset:4096
    s_waitcnt lgkmcnt(14)
    v_mfma_f32_32x32x16_bf16 v[128:143], a[40:43], v[72:75], v[128:143]
    s_waitcnt lgkmcnt(12)
    s_add_u32 m0, s53, 20480
    s_add_u32 s60, s52, 1310720
    buffer_load_dwordx4 v10, s[32:35], s60 offen lds
    v_mfma_f32_32x32x16_bf16 v[144:159], a[40:43], v[76:79], v[144:159]
    buffer_load_dwordx4 v11, s[32:35], s60 offen offset:1024 lds
    v_mfma_f32_32x32x16_bf16 v[160:175], a[44:47], v[72:75], v[160:175]
    buffer_load_dwordx4 v12, s[32:35], s60 offen offset:2048 lds
    v_mfma_f32_32x32x16_bf16 v[176:191], a[44:47], v[76:79], v[176:191]
    s_waitcnt lgkmcnt(7)
    v_mfma_f32_32x32x16_bf16 v[128:143], a[48:51], v[80:83], v[128:143]
    s_waitcnt lgkmcnt(1)
    ds_read_b128 v[64:67], v96 offset:40960
    v_mfma_f32_32x32x16_bf16 v[144:159], a[48:51], v[84:87], v[144:159]
    ds_read_b128 v[68:71], v96 offset:45056
    v_mfma_f32_32x32x16_bf16 v[160:175], a[52:55], v[80:83], v[160:175]
    buffer_load_dwordx4 v13, s[32:35], s60 offen offset:3072 lds
    s_waitcnt vmcnt(12)
    ds_read_b64_tr_b16 a[64:65], v23 offset:32768
    ds_read_b64_tr_b16 a[66:67], v23 offset:33280
    ds_read_b128 v[72:75], v97 offset:40960
    ds_read_b64_tr_b16 a[68:69], v24 offset:32768
    ds_read_b64_tr_b16 a[70:71], v24 offset:33280
    ds_read_b64_tr_b16 a[72:73], v23 offset:34816
    ds_read_b64_tr_b16 a[74:75], v23 offset:35328
    ds_read_b64_tr_b16 a[76:77], v24 offset:34816
    ds_read_b64_tr_b16 a[78:79], v24 offset:35328
    v_mfma_f32_32x32x16_bf16 v[176:191], a[52:55], v[84:87], v[176:191]
    s_add_u32 m0, s53, 24576
    s_add_u32 s60, s52, 1572864
    buffer_load_dwordx4 v10, s[32:35], s60 offen lds
    ds_read_b128 v[76:79], v97 offset:45056
    v_mfma_f32_32x32x16_bf16 v[128:143], a[56:59], v[88:91], v[128:143]
    buffer_load_dwordx4 v11, s[32:35], s60 offen offset:1024 lds
    s_waitcnt lgkmcnt(12)
    v_mfma_f32_32x32x16_bf16 v[144:159], a[56:59], v[92:95], v[144:159]
    buffer_load_dwordx4 v12, s[32:35], s60 offen offset:2048 lds
    v_mfma_f32_32x32x16_bf16 v[160:175], a[60:63], v[88:91], v[160:175]
    v_mfma_f32_32x32x16_bf16 v[176:191], a[60:63], v[92:95], v[176:191]
    buffer_load_dwordx4 v13, s[32:35], s60 offen offset:3072 lds
    s_waitcnt vmcnt(12)
    ds_read_b64_tr_b16 a[80:81], v23 offset:36864
    ds_read_b64_tr_b16 a[82:83], v23 offset:37376
    s_waitcnt lgkmcnt(10)
    v_mfma_f32_32x32x16_bf16 v[128:143], a[64:67], v[64:67], v[128:143]
    s_waitcnt lgkmcnt(3)
    s_add_u32 m0, s53, 28672
    s_add_u32 s60, s52, 1835008
    buffer_load_dwordx4 v10, s[32:35], s60 offen lds
    ds_read_b64_tr_b16 a[84:85], v24 offset:36864
    ds_read_b64_tr_b16 a[86:87], v24 offset:37376
    ds_read_b128 v[80:83], v98 offset:40960
    v_mfma_f32_32x32x16_bf16 v[144:159], a[64:67], v[68:71], v[144:159]
    buffer_load_dwordx4 v11, s[32:35], s60 offen offset:1024 lds
    ds_read_b64_tr_b16 a[88:89], v23 offset:38912
    ds_read_b64_tr_b16 a[90:91], v23 offset:39424
    ds_read_b128 v[84:87], v98 offset:45056
    v_mfma_f32_32x32x16_bf16 v[160:175], a[68:71], v[64:67], v[160:175]
    buffer_load_dwordx4 v12, s[32:35], s60 offen offset:2048 lds
    ds_read_b64_tr_b16 a[92:93], v24 offset:38912
    ds_read_b64_tr_b16 a[94:95], v24 offset:39424
    ds_read_b128 v[88:91], v99 offset:40960
    v_mfma_f32_32x32x16_bf16 v[176:191], a[68:71], v[68:71], v[176:191]
    buffer_load_dwordx4 v13, s[32:35], s60 offen offset:3072 lds
    s_waitcnt vmcnt(12)
    ds_read_b64_tr_b16 a[96:97], v23 offset:16384
    ds_read_b64_tr_b16 a[98:99], v23 offset:16896
    ds_read_b128 v[92:95], v99 offset:45056
    v_mfma_f32_32x32x16_bf16 v[128:143], a[72:75], v[72:75], v[128:143]
    ds_read_b64_tr_b16 a[100:101], v24 offset:16384
    ds_read_b64_tr_b16 a[102:103], v24 offset:16896
    s_waitcnt lgkmcnt(14)
    v_mfma_f32_32x32x16_bf16 v[144:159], a[72:75], v[76:79], v[144:159]
    s_add_u32 m0, s53, 32768
    s_add_u32 s60, s52, 2097152
    buffer_load_dwordx4 v10, s[32:35], s60 offen lds
    ds_read_b64_tr_b16 a[104:105], v23 offset:18432
    ds_read_b64_tr_b16 a[106:107], v23 offset:18944
    v_mfma_f32_32x32x16_bf16 v[160:175], a[76:79], v[72:75], v[160:175]
    buffer_load_dwordx4 v11, s[32:35], s60 offen offset:1024 lds
    ds_read_b64_tr_b16 a[108:109], v24 offset:18432
    ds_read_b64_tr_b16 a[110:111], v24 offset:18944
    v_mfma_f32_32x32x16_bf16 v[176:191], a[76:79], v[76:79], v[176:191]
    buffer_load_dwordx4 v12, s[32:35], s60 offen offset:2048 lds
    s_waitcnt lgkmcnt(14)
    v_mfma_f32_32x32x16_bf16 v[128:143], a[80:83], v[80:83], v[128:143]
    s_waitcnt lgkmcnt(10)
    buffer_load_dwordx4 v13, s[32:35], s60 offen offset:3072 lds
    s_waitcnt vmcnt(12)
    ds_read_b64_tr_b16 a[112:113], v23 offset:20480
    ds_read_b64_tr_b16 a[114:115], v23 offset:20992
    ds_read_b128 v[64:67], v100 offset:16384
    v_mfma_f32_32x32x16_bf16 v[144:159], a[80:83], v[84:87], v[144:159]
    ds_read_b64_tr_b16 a[116:117], v24 offset:20480
    ds_read_b64_tr_b16 a[118:119], v24 offset:20992
    ds_read_b128 v[68:71], v100 offset:20480
    v_mfma_f32_32x32x16_bf16 v[160:175], a[84:87], v[80:83], v[160:175]
    s_add_u32 m0, s53, 36864
    s_add_u32 s60, s52, 2359296
    buffer_load_dwordx4 v10, s[32:35], s60 offen lds
    ds_read_b64_tr_b16 a[120:121], v23 offset:22528
    ds_read_b64_tr_b16 a[122:123], v23 offset:23040
    ds_read_b128 v[72:75], v101 offset:16384
    ds_read_b64_tr_b16 a[124:125], v24 offset:22528
    ds_read_b64_tr_b16 a[126:127], v24 offset:23040
    v_mfma_f32_32x32x16_bf16 v[176:191], a[84:87], v[84:87], v[176:191]
    buffer_load_dwordx4 v11, s[32:35], s60 offen offset:1024 lds
    ds_read_b128 v[76:79], v101 offset:20480
    s_waitcnt lgkmcnt(14)
    v_mfma_f32_32x32x16_bf16 v[128:143], a[88:91], v[88:91], v[128:143]
    s_waitcnt lgkmcnt(12)
    buffer_load_dwordx4 v12, s[32:35], s60 offen offset:2048 lds
    v_mfma_f32_32x32x16_bf16 v[144:159], a[88:91], v[92:95], v[144:159]
    buffer_load_dwordx4 v13, s[32:35], s60 offen offset:3072 lds
    s_waitcnt vmcnt(12)
    ds_read_b64_tr_b16 a[128:129], v23 offset:24576
    ds_read_b64_tr_b16 a[130:131], v23 offset:25088
    v_mfma_f32_32x32x16_bf16 v[160:175], a[92:95], v[88:91], v[160:175]
    s_add_u32 m0, s53, 16384
    s_add_u32 s60, s52, 2621440
    buffer_load_dwordx4 v10, s[32:35], s60 offen lds
    ds_read_b64_tr_b16 a[132:133], v24 offset:24576
    ds_read_b64_tr_b16 a[134:135], v24 offset:25088
    v_mfma_f32_32x32x16_bf16 v[176:191], a[92:95], v[92:95], v[176:191]
    buffer_load_dwordx4 v11, s[32:35], s60 offen offset:1024 lds
    ds_read_b64_tr_b16 a[136:137], v23 offset:26624
    ds_read_b64_tr_b16 a[138:139], v23 offset:27136
    s_waitcnt lgkmcnt(14)
    v_mfma_f32_32x32x16_bf16 v[128:143], a[96:99], v[64:67], v[128:143]
    s_waitcnt lgkmcnt(7)
    ds_read_b64_tr_b16 a[140:141], v24 offset:26624
    ds_read_b64_tr_b16 a[142:143], v24 offset:27136
    ds_read_b128 v[80:83], v102 offset:16384
    v_mfma_f32_32x32x16_bf16 v[144:159], a[96:99], v[68:71], v[144:159]
    buffer_load_dwordx4 v12, s[32:35], s60 offen offset:2048 lds
    ds_read_b128 v[84:87], v102 offset:20480
    v_mfma_f32_32x32x16_bf16 v[160:175], a[100:103], v[64:67], v[160:175]
    buffer_load_dwordx4 v13, s[32:35], s60 offen offset:3072 lds
    s_waitcnt vmcnt(12)
    ds_read_b64_tr_b16 a[144:145], v23 offset:28672
    ds_read_b64_tr_b16 a[146:147], v23 offset:29184
    ds_read_b128 v[88:91], v103 offset:16384
    ds_read_b64_tr_b16 a[148:149], v24 offset:28672
    ds_read_b64_tr_b16 a[150:151], v24 offset:29184
    ds_read_b64_tr_b16 a[152:153], v23 offset:30720
    ds_read_b64_tr_b16 a[154:155], v23 offset:31232
    ds_read_b64_tr_b16 a[156:157], v24 offset:30720
    ds_read_b64_tr_b16 a[158:159], v24 offset:31232
    v_mfma_f32_32x32x16_bf16 v[176:191], a[100:103], v[68:71], v[176:191]
    s_add_u32 m0, s53, 20480
    s_add_u32 s60, s52, 2883584
    buffer_load_dwordx4 v10, s[32:35], s60 offen lds
    ds_read_b128 v[92:95], v103 offset:20480
    v_mfma_f32_32x32x16_bf16 v[128:143], a[104:107], v[72:75], v[128:143]
    buffer_load_dwordx4 v11, s[32:35], s60 offen offset:1024 lds
    s_waitcnt lgkmcnt(14)
    v_mfma_f32_32x32x16_bf16 v[144:159], a[104:107], v[76:79], v[144:159]
    s_waitcnt lgkmcnt(12)
    buffer_load_dwordx4 v12, s[32:35], s60 offen offset:2048 lds
    v_mfma_f32_32x32x16_bf16 v[160:175], a[108:111], v[72:75], v[160:175]
    buffer_load_dwordx4 v13, s[32:35], s60 offen offset:3072 lds
    s_waitcnt vmcnt(12)
    ds_read_b64_tr_b16 a[160:161], v23 offset:32768
    ds_read_b64_tr_b16 a[162:163], v23 offset:33280
    v_mfma_f32_32x32x16_bf16 v[176:191], a[108:111], v[76:79], v[176:191]
    ds_read_b64_tr_b16 a[164:165], v24 offset:32768
    ds_read_b64_tr_b16 a[166:167], v24 offset:33280
    s_waitcnt lgkmcnt(14)
    v_mfma_f32_32x32x16_bf16 v[128:143], a[112:115], v[80:83], v[128:143]
    s_waitcnt lgkmcnt(5)
    s_add_u32 m0, s53, 24576
    s_add_u32 s60, s52, 3145728
    buffer_load_dwordx4 v10, s[32:35], s60 offen lds
    ds_read_b64_tr_b16 a[168:169], v23 offset:34816
    ds_read_b64_tr_b16 a[170:171], v23 offset:35328
    ds_read_b128 v[64:67], v100 offset:57344
    v_mfma_f32_32x32x16_bf16 v[144:159], a[112:115], v[84:87], v[144:159]
    buffer_load_dwordx4 v11, s[32:35], s60 offen offset:1024 lds
    ds_read_b64_tr_b16 a[172:173], v24 offset:34816
    ds_read_b64_tr_b16 a[174:175], v24 offset:35328
    ds_read_b128 v[68:71], v100 offset:61440
    v_mfma_f32_32x32x16_bf16 v[160:175], a[116:119], v[80:83], v[160:175]
    buffer_load_dwordx4 v12, s[32:35], s60 offen offset:2048 lds
    ds_read_b128 v[72:75], v101 offset:57344
    v_mfma_f32_32x32x16_bf16 v[176:191], a[116:119], v[84:87], v[176:191]
    buffer_load_dwordx4 v13, s[32:35], s60 offen offset:3072 lds
    s_waitcnt vmcnt(12)
    ds_read_b64_tr_b16 a[176:177], v23 offset:36864
    ds_read_b64_tr_b16 a[178:179], v23 offset:37376
    ds_read_b128 v[76:79], v101 offset:61440
    v_mfma_f32_32x32x16_bf16 v[128:143], a[120:123], v[88:91], v[128:143]
    ds_read_b64_tr_b16 a[180:181], v24 offset:36864
    ds_read_b64_tr_b16 a[182:183], v24 offset:37376
    s_waitcnt lgkmcnt(14)
    v_mfma_f32_32x32x16_bf16 v[144:159], a[120:123], v[92:95], v[144:159]
    s_add_u32 m0, s53, 28672
    s_add_u32 s60, s52, 3407872
    buffer_load_dwordx4 v10, s[32:35], s60 offen lds
    ds_read_b64_tr_b16 a[184:185], v23 offset:38912
    ds_read_b64_tr_b16 a[186:187], v23 offset:39424
    v_mfma_f32_32x32x16_bf16 v[160:175], a[124:127], v[88:91], v[160:175]
    buffer_load_dwordx4 v11, s[32:35], s60 offen offset:1024 lds
    ds_read_b64_tr_b16 a[188:189], v24 offset:38912
    ds_read_b64_tr_b16 a[190:191], v24 offset:39424
    v_mfma_f32_32x32x16_bf16 v[176:191], a[124:127], v[92:95], v[176:191]
    s_waitcnt lgkmcnt(11)
    buffer_load_dwordx4 v12, s[32:35], s60 offen offset:2048 lds
    v_mfma_f32_32x32x16_bf16 v[128:143], a[128:131], v[64:67], v[128:143]
    buffer_load_dwordx4 v13, s[32:35], s60 offen offset:3072 lds
    s_waitcnt vmcnt(12)
    ds_read_b64_tr_b16 a[192:193], v23 offset:16384
    ds_read_b64_tr_b16 a[194:195], v23 offset:16896
    ds_read_b128 v[80:83], v102 offset:57344
    s_waitcnt lgkmcnt(13)
    v_mfma_f32_32x32x16_bf16 v[144:159], a[128:131], v[68:71], v[144:159]
    ds_read_b64_tr_b16 a[196:197], v24 offset:16384
    ds_read_b64_tr_b16 a[198:199], v24 offset:16896
    ds_read_b128 v[84:87], v102 offset:61440
    v_mfma_f32_32x32x16_bf16 v[160:175], a[132:135], v[64:67], v[160:175]
    ds_read_b64_tr_b16 a[200:201], v23 offset:18432
    ds_read_b64_tr_b16 a[202:203], v23 offset:18944
    ds_read_b128 v[88:91], v103 offset:57344
    ds_read_b64_tr_b16 a[204:205], v24 offset:18432
    ds_read_b64_tr_b16 a[206:207], v24 offset:18944
    v_mfma_f32_32x32x16_bf16 v[176:191], a[132:135], v[68:71], v[176:191]
    ds_read_b128 v[92:95], v103 offset:61440
    s_waitcnt lgkmcnt(14)
    v_mfma_f32_32x32x16_bf16 v[128:143], a[136:139], v[72:75], v[128:143]
    s_waitcnt lgkmcnt(12)
    v_mfma_f32_32x32x16_bf16 v[144:159], a[136:139], v[76:79], v[144:159]
    v_mfma_f32_32x32x16_bf16 v[160:175], a[140:143], v[72:75], v[160:175]
    s_waitcnt vmcnt(8)
    ds_read_b64_tr_b16 a[208:209], v23 offset:20480
    ds_read_b64_tr_b16 a[210:211], v23 offset:20992
    v_mfma_f32_32x32x16_bf16 v[176:191], a[140:143], v[76:79], v[176:191]
    ds_read_b64_tr_b16 a[212:213], v24 offset:20480
    ds_read_b64_tr_b16 a[214:215], v24 offset:20992
    s_waitcnt lgkmcnt(13)
    v_mfma_f32_32x32x16_bf16 v[128:143], a[144:147], v[80:83], v[128:143]
    s_waitcnt lgkmcnt(5)
    s_add_u32 m0, s53, 32768
    s_add_u32 s60, s48, 256
    buffer_load_dwordx4 v2, s[24:27], s60 offen nt lds
    ds_read_b64_tr_b16 a[216:217], v23 offset:22528
    ds_read_b64_tr_b16 a[218:219], v23 offset:23040
    ds_read_b128 v[64:67], v96 offset:8192
    v_mfma_f32_32x32x16_bf16 v[144:159], a[144:147], v[84:87], v[144:159]
    buffer_load_dwordx4 v3, s[24:27], s60 offen offset:1024 nt lds
    ds_read_b64_tr_b16 a[220:221], v24 offset:22528
    ds_read_b64_tr_b16 a[222:223], v24 offset:23040
    ds_read_b128 v[68:71], v96 offset:12288
    v_mfma_f32_32x32x16_bf16 v[160:175], a[148:151], v[80:83], v[160:175]
    buffer_load_dwordx4 v4, s[24:27], s60 offen offset:2048 nt lds
    s_waitcnt vmcnt(7)
    ds_read_b64_tr_b16 a[224:225], v23 offset:24576
    ds_read_b64_tr_b16 a[226:227], v23 offset:25088
    ds_read_b128 v[72:75], v97 offset:8192
    ds_read_b64_tr_b16 a[228:229], v24 offset:24576
    ds_read_b64_tr_b16 a[230:231], v24 offset:25088
    ds_read_b64_tr_b16 a[232:233], v23 offset:26624
    ds_read_b64_tr_b16 a[234:235], v23 offset:27136
    ds_read_b64_tr_b16 a[236:237], v24 offset:26624
    ds_read_b64_tr_b16 a[238:239], v24 offset:27136
    v_mfma_f32_32x32x16_bf16 v[176:191], a[148:151], v[84:87], v[176:191]
    buffer_load_dwordx4 v5, s[24:27], s60 offen offset:3072 nt lds
    ds_read_b128 v[76:79], v97 offset:12288
    v_mfma_f32_32x32x16_bf16 v[128:143], a[152:155], v[88:91], v[128:143]
    s_waitcnt lgkmcnt(14)
    v_mfma_f32_32x32x16_bf16 v[144:159], a[152:155], v[92:95], v[144:159]
    v_mfma_f32_32x32x16_bf16 v[160:175], a[156:159], v[88:91], v[160:175]
    s_waitcnt lgkmcnt(11)
    s_add_u32 m0, s53, 36864
    s_add_u32 s60, s48, 384
    buffer_load_dwordx4 v2, s[24:27], s60 offen nt lds
    s_waitcnt vmcnt(5)
    ds_read_b64_tr_b16 a[240:241], v23 offset:28672
    ds_read_b64_tr_b16 a[242:243], v23 offset:29184
    v_mfma_f32_32x32x16_bf16 v[176:191], a[156:159], v[92:95], v[176:191]
    buffer_load_dwordx4 v3, s[24:27], s60 offen offset:1024 nt lds
    ds_read_b64_tr_b16 a[244:245], v24 offset:28672
    ds_read_b64_tr_b16 a[246:247], v24 offset:29184
    v_mfma_f32_32x32x16_bf16 v[128:143], a[160:163], v[64:67], v[128:143]
    s_waitcnt lgkmcnt(5)
    buffer_load_dwordx4 v4, s[24:27], s60 offen offset:2048 nt lds
    ds_read_b64_tr_b16 a[248:249], v23 offset:30720
    ds_read_b64_tr_b16 a[250:251], v23 offset:31232
    ds_read_b128 v[80:83], v98 offset:8192
    s_barrier
    v_mfma_f32_32x32x16_bf16 v[144:159], a[160:163], v[68:71], v[144:159]
    buffer_load_dwordx4 v5, s[24:27], s60 offen offset:3072 nt lds
    ds_read_b64_tr_b16 a[252:253], v24 offset:30720
    ds_read_b64_tr_b16 a[254:255], v24 offset:31232
    ds_read_b128 v[84:87], v98 offset:12288
    v_mfma_f32_32x32x16_bf16 v[160:175], a[164:167], v[64:67], v[160:175]
    s_add_u32 m0, s53, 16384
    s_add_u32 s60, s49, 16384
    buffer_load_dwordx4 v2, s[24:27], s60 offen nt lds
    ds_read_b128 v[88:91], v99 offset:8192
    v_mfma_f32_32x32x16_bf16 v[176:191], a[164:167], v[68:71], v[176:191]
    buffer_load_dwordx4 v3, s[24:27], s60 offen offset:1024 nt lds
    ds_read_b128 v[92:95], v99 offset:12288
    v_mfma_f32_32x32x16_bf16 v[128:143], a[168:171], v[72:75], v[128:143]
    buffer_load_dwordx4 v4, s[24:27], s60 offen offset:2048 nt lds
    s_waitcnt lgkmcnt(12)
    v_mfma_f32_32x32x16_bf16 v[144:159], a[168:171], v[76:79], v[144:159]
    buffer_load_dwordx4 v5, s[24:27], s60 offen offset:3072 nt lds
    v_mfma_f32_32x32x16_bf16 v[160:175], a[172:175], v[72:75], v[160:175]
    v_mfma_f32_32x32x16_bf16 v[176:191], a[172:175], v[76:79], v[176:191]
    s_waitcnt lgkmcnt(3)
    v_mfma_f32_32x32x16_bf16 v[128:143], a[176:179], v[80:83], v[128:143]
    ds_read_b128 v[64:67], v96 offset:49152
    s_waitcnt lgkmcnt(3)
    v_mfma_f32_32x32x16_bf16 v[144:159], a[176:179], v[84:87], v[144:159]
    ds_read_b128 v[68:71], v96 offset:53248
    v_mfma_f32_32x32x16_bf16 v[160:175], a[180:183], v[80:83], v[160:175]
    ds_read_b128 v[72:75], v97 offset:49152
    v_mfma_f32_32x32x16_bf16 v[176:191], a[180:183], v[84:87], v[176:191]
    ds_read_b128 v[76:79], v97 offset:53248
    s_waitcnt lgkmcnt(5)
    v_mfma_f32_32x32x16_bf16 v[128:143], a[184:187], v[88:91], v[128:143]
    s_waitcnt lgkmcnt(4)
    v_mfma_f32_32x32x16_bf16 v[144:159], a[184:187], v[92:95], v[144:159]
    v_mfma_f32_32x32x16_bf16 v[160:175], a[188:191], v[88:91], v[160:175]
    v_mfma_f32_32x32x16_bf16 v[176:191], a[188:191], v[92:95], v[176:191]
    s_waitcnt lgkmcnt(3)
    v_mfma_f32_32x32x16_bf16 v[128:143], a[192:195], v[64:67], v[128:143]
    ds_read_b128 v[80:83], v98 offset:49152
    s_waitcnt lgkmcnt(3)
    v_mfma_f32_32x32x16_bf16 v[144:159], a[192:195], v[68:71], v[144:159]
    ds_read_b128 v[84:87], v98 offset:53248
    v_mfma_f32_32x32x16_bf16 v[160:175], a[196:199], v[64:67], v[160:175]
    ds_read_b128 v[88:91], v99 offset:49152
    v_mfma_f32_32x32x16_bf16 v[176:191], a[196:199], v[68:71], v[176:191]
    ds_read_b128 v[92:95], v99 offset:53248
    s_waitcnt lgkmcnt(5)
    v_mfma_f32_32x32x16_bf16 v[128:143], a[200:203], v[72:75], v[128:143]
    s_waitcnt lgkmcnt(4)
    v_mfma_f32_32x32x16_bf16 v[144:159], a[200:203], v[76:79], v[144:159]
    v_mfma_f32_32x32x16_bf16 v[160:175], a[204:207], v[72:75], v[160:175]
    v_mfma_f32_32x32x16_bf16 v[176:191], a[204:207], v[76:79], v[176:191]
    s_waitcnt lgkmcnt(3)
    v_mfma_f32_32x32x16_bf16 v[128:143], a[208:211], v[80:83], v[128:143]
    s_add_u32 m0, s53, 20480
    s_add_u32 s60, s49, 16512
    buffer_load_dwordx4 v2, s[24:27], s60 offen nt lds
    ds_read_b128 v[64:67], v100 offset:24576
    s_waitcnt lgkmcnt(3)
    v_mfma_f32_32x32x16_bf16 v[144:159], a[208:211], v[84:87], v[144:159]
    ds_read_b128 v[68:71], v100 offset:28672
    v_mfma_f32_32x32x16_bf16 v[160:175], a[212:215], v[80:83], v[160:175]
    ds_read_b128 v[72:75], v101 offset:24576
    v_mfma_f32_32x32x16_bf16 v[176:191], a[212:215], v[84:87], v[176:191]
    buffer_load_dwordx4 v3, s[24:27], s60 offen offset:1024 nt lds
    ds_read_b128 v[76:79], v101 offset:28672
    s_waitcnt lgkmcnt(5)
    v_mfma_f32_32x32x16_bf16 v[128:143], a[216:219], v[88:91], v[128:143]
    s_waitcnt lgkmcnt(4)
    v_mfma_f32_32x32x16_bf16 v[144:159], a[216:219], v[92:95], v[144:159]
    v_mfma_f32_32x32x16_bf16 v[160:175], a[220:223], v[88:91], v[160:175]
    buffer_load_dwordx4 v4, s[24:27], s60 offen offset:2048 nt lds
    v_mfma_f32_32x32x16_bf16 v[176:191], a[220:223], v[92:95], v[176:191]
    s_waitcnt lgkmcnt(3)
    v_mfma_f32_32x32x16_bf16 v[128:143], a[224:227], v[64:67], v[128:143]
    ds_read_b128 v[80:83], v102 offset:24576
    s_waitcnt lgkmcnt(3)
    v_mfma_f32_32x32x16_bf16 v[144:159], a[224:227], v[68:71], v[144:159]
    buffer_load_dwordx4 v5, s[24:27], s60 offen offset:3072 nt lds
    s_waitcnt vmcnt(12)
    ds_read_b128 a[32:35], v19 offset:32768
    ds_read_b128 a[36:39], v20 offset:32768
    ds_read_b128 v[84:87], v102 offset:28672
    v_mfma_f32_32x32x16_bf16 v[160:175], a[228:231], v[64:67], v[160:175]
    ds_read_b128 a[40:43], v21 offset:32768
    ds_read_b128 a[44:47], v22 offset:32768
    ds_read_b128 v[88:91], v103 offset:24576
    v_mfma_f32_32x32x16_bf16 v[176:191], a[228:231], v[68:71], v[176:191]
    ds_read_b128 v[92:95], v103 offset:28672
    s_waitcnt lgkmcnt(9)
    v_mfma_f32_32x32x16_bf16 v[128:143], a[232:235], v[72:75], v[128:143]
    s_add_u32 m0, s53, 24576
    s_add_u32 s60, s49, 16640
    buffer_load_dwordx4 v2, s[24:27], s60 offen nt lds
    s_waitcnt lgkmcnt(8)
    v_mfma_f32_32x32x16_bf16 v[144:159], a[232:235], v[76:79], v[144:159]
    v_mfma_f32_32x32x16_bf16 v[160:175], a[236:239], v[72:75], v[160:175]
    v_mfma_f32_32x32x16_bf16 v[176:191], a[236:239], v[76:79], v[176:191]
    buffer_load_dwordx4 v3, s[24:27], s60 offen offset:1024 nt lds
    s_waitcnt lgkmcnt(7)
    v_mfma_f32_32x32x16_bf16 v[128:143], a[240:243], v[80:83], v[128:143]
    s_waitcnt lgkmcnt(2)
    v_mfma_f32_32x32x16_bf16 v[144:159], a[240:243], v[84:87], v[144:159]
    v_mfma_f32_32x32x16_bf16 v[160:175], a[244:247], v[80:83], v[160:175]
    v_mfma_f32_32x32x16_bf16 v[176:191], a[244:247], v[84:87], v[176:191]
    buffer_load_dwordx4 v4, s[24:27], s60 offen offset:2048 nt lds
    s_waitcnt lgkmcnt(1)
    v_mfma_f32_32x32x16_bf16 v[128:143], a[248:251], v[88:91], v[128:143]
    s_waitcnt lgkmcnt(0)
    v_mfma_f32_32x32x16_bf16 v[144:159], a[248:251], v[92:95], v[144:159]
    v_mfma_f32_32x32x16_bf16 v[160:175], a[252:255], v[88:91], v[160:175]
    buffer_load_dwordx4 v5, s[24:27], s60 offen offset:3072 nt lds
    s_waitcnt vmcnt(12)
    ds_read_b128 a[48:51], v19 offset:36864
    ds_read_b128 a[52:55], v20 offset:36864
    v_mfma_f32_32x32x16_bf16 v[176:191], a[252:255], v[92:95], v[176:191]
    ds_read_b128 a[56:59], v21 offset:36864
    ds_read_b128 a[60:63], v22 offset:36864
    s_nop 1
    v_cvt_pk_bf16_f32 v32, v128, v129
    v_cvt_pk_bf16_f32 v33, v130, v131
    v_cvt_pk_bf16_f32 v34, v132, v133
    v_cvt_pk_bf16_f32 v35, v134, v135
    ds_write_b128 v27, v[32:35] offset:0
    v_cvt_pk_bf16_f32 v40, v136, v137
    s_add_u32 m0, s53, 28672
    s_add_u32 s60, s49, 16768
    buffer_load_dwordx4 v2, s[24:27], s60 offen nt lds
    v_cvt_pk_bf16_f32 v41, v138, v139
    v_cvt_pk_bf16_f32 v42, v140, v141
    v_cvt_pk_bf16_f32 v43, v142, v143
    ds_write_b128 v27, v[40:43] offset:2048
    v_cvt_pk_bf16_f32 v36, v144, v145
    v_cvt_pk_bf16_f32 v37, v146, v147
    v_cvt_pk_bf16_f32 v38, v148, v149
    v_cvt_pk_bf16_f32 v39, v150, v151
    ds_write_b128 v27, v[36:39] offset:1024
    v_cvt_pk_bf16_f32 v44, v152, v153
    v_cvt_pk_bf16_f32 v45, v154, v155
    v_cvt_pk_bf16_f32 v46, v156, v157
    v_cvt_pk_bf16_f32 v47, v158, v159
    buffer_load_dwordx4 v3, s[24:27], s60 offen offset:1024 nt lds
    ds_write_b128 v27, v[44:47] offset:3072
    s_waitcnt lgkmcnt(4)
    v_cvt_pk_bf16_f32 v48, v160, v161
    v_cvt_pk_bf16_f32 v49, v162, v163
    v_cvt_pk_bf16_f32 v50, v164, v165
    v_cvt_pk_bf16_f32 v51, v166, v167
    ds_write_b128 v27, v[48:51] offset:4096
    v_cvt_pk_bf16_f32 v56, v168, v169
    v_cvt_pk_bf16_f32 v57, v170, v171
    v_cvt_pk_bf16_f32 v58, v172, v173
    v_cvt_pk_bf16_f32 v59, v174, v175
    ds_write_b128 v27, v[56:59] offset:6144
    v_cvt_pk_bf16_f32 v52, v176, v177
    v_cvt_pk_bf16_f32 v53, v178, v179
    v_cvt_pk_bf16_f32 v54, v180, v181
    buffer_load_dwordx4 v4, s[24:27], s60 offen offset:2048 nt lds
    v_cvt_pk_bf16_f32 v55, v182, v183
    ds_write_b128 v27, v[52:55] offset:5120
    v_cvt_pk_bf16_f32 v60, v184, v185
    v_cvt_pk_bf16_f32 v61, v186, v187
    v_cvt_pk_bf16_f32 v62, v188, v189
    v_cvt_pk_bf16_f32 v63, v190, v191
    ds_write_b128 v27, v[60:63] offset:7168
    s_waitcnt lgkmcnt(0)
    s_barrier
    ds_read_b128 a[64:67], v28 offset:0
    buffer_load_dwordx4 v5, s[24:27], s60 offen offset:3072 nt lds
    s_waitcnt vmcnt(12)
    ds_read_b128 a[192:195], v19 offset:16384
    ds_read_b128 a[68:71], v28 offset:1024
    ds_read_b128 a[196:199], v20 offset:16384
    ds_read_b128 a[72:75], v28 offset:2048
    ds_read_b128 a[200:203], v21 offset:16384
    ds_read_b128 a[76:79], v28 offset:3072
    ds_read_b128 a[204:207], v22 offset:16384
    ds_read_b128 a[80:83], v28 offset:4096
    ds_read_b128 a[84:87], v28 offset:5120
    ds_read_b128 a[88:91], v28 offset:6144
    s_add_u32 m0, s53, 32768
    s_add_u32 s60, s48, 32768
    buffer_load_dwordx4 v2, s[24:27], s60 offen nt lds
    ds_read_b128 a[92:95], v28 offset:7168
    ds_read_b128 a[96:99], v28 offset:40960
    ds_read_b128 a[100:103], v28 offset:41984
    s_waitcnt lgkmcnt(13)
    v_mfma_f32_32x32x16_bf16 v[128:143], a[0:3], a[64:67], 0
    ds_read_b128 a[104:107], v28 offset:43008
    ds_read_b128 a[108:111], v28 offset:44032
    s_waitcnt lgkmcnt(13)
    v_mfma_f32_32x32x16_bf16 v[144:159], a[0:3], a[68:71], 0
    ds_read_b128 a[112:115], v28 offset:45056
    ds_read_b128 a[116:119], v28 offset:46080
    s_waitcnt lgkmcnt(13)
    v_mfma_f32_32x32x16_bf16 v[128:143], a[4:7], a[72:75], v[128:143]
    buffer_load_dwordx4 v3, s[24:27], s60 offen offset:1024 nt lds
    ds_read_b128 a[120:123], v28 offset:47104
    ds_read_b128 a[124:127], v28 offset:48128
    s_waitcnt lgkmcnt(13)
    v_mfma_f32_32x32x16_bf16 v[144:159], a[4:7], a[76:79], v[144:159]
    ds_read_b128 a[128:131], v29 offset:16384
    ds_read_b128 a[132:135], v29 offset:17408
    s_waitcnt lgkmcnt(13)
    v_mfma_f32_32x32x16_bf16 v[128:143], a[8:11], a[80:83], v[128:143]
    ds_read_b128 a[136:139], v29 offset:18432
    ds_read_b128 a[140:143], v29 offset:19456
    s_waitcnt lgkmcnt(14)
    v_mfma_f32_32x32x16_bf16 v[144:159], a[8:11], a[84:87], v[144:159]
    buffer_load_dwordx4 v4, s[24:27], s60 offen offset:2048 nt lds
    ds_read_b128 a[144:147], v29 offset:20480
    ds_read_b128 a[148:151], v29 offset:21504
    s_waitcnt lgkmcnt(14)
    v_mfma_f32_32x32x16_bf16 v[128:143], a[12:15], a[88:91], v[128:143]
    ds_read_b128 a[152:155], v29 offset:22528
    ds_read_b128 a[156:159], v29 offset:23552
    v_mfma_f32_32x32x16_bf16 v[144:159], a[12:15], a[92:95], v[144:159]
    ds_read_b128 a[160:163], v29 offset:57344
    ds_read_b128 a[164:167], v29 offset:58368
    s_waitcnt lgkmcnt(14)
    v_mfma_f32_32x32x16_bf16 v[128:143], a[16:19], a[96:99], v[128:143]
    ds_read_b128 a[168:171], v29 offset:59392
    ds_read_b128 a[172:175], v29 offset:60416
    v_mfma_f32_32x32x16_bf16 v[144:159], a[16:19], a[100:103], v[144:159]
    buffer_load_dwordx4 v5, s[24:27], s60 offen offset:3072 nt lds
    s_waitcnt vmcnt(12)
    ds_read_b128 a[208:211], v19 offset:20480
    ds_read_b128 a[212:215], v20 offset:20480
    ds_read_b128 a[176:179], v29 offset:61440
    ds_read_b128 a[180:183], v29 offset:62464
    v_mfma_f32_32x32x16_bf16 v[128:143], a[20:23], a[104:107], v[128:143]
    ds_read_b128 a[216:219], v21 offset:20480
    ds_read_b128 a[220:223], v22 offset:20480
    ds_read_b128 a[184:187], v29 offset:63488
    ds_read_b128 a[188:191], v29 offset:64512
    v_mfma_f32_32x32x16_bf16 v[144:159], a[20:23], a[108:111], v[144:159]
    s_waitcnt lgkmcnt(14)
    v_mfma_f32_32x32x16_bf16 v[128:143], a[24:27], a[112:115], v[128:143]
    s_add_u32 m0, s53, 36864
    s_add_u32 s60, s48, 32896
    buffer_load_dwordx4 v2, s[24:27], s60 offen nt lds
    v_mfma_f32_32x32x16_bf16 v[144:159], a[24:27], a[116:119], v[144:159]
    v_mfma_f32_32x32x16_bf16 v[128:143], a[28:31], a[120:123], v[128:143]
    v_mfma_f32_32x32x16_bf16 v[144:159], a[28:31], a[124:127], v[144:159]
    buffer_load_dwordx4 v3, s[24:27], s60 offen offset:1024 nt lds
    v_mfma_f32_32x32x16_bf16 v[128:143], a[32:35], a[128:131], v[128:143]
    s_waitcnt lgkmcnt(2)
    v_mfma_f32_32x32x16_bf16 v[144:159], a[32:35], a[132:135], v[144:159]
    v_mfma_f32_32x32x16_bf16 v[128:143], a[36:39], a[136:139], v[128:143]
    buffer_load_dwordx4 v4, s[24:27], s60 offen offset:2048 nt lds
    v_mfma_f32_32x32x16_bf16 v[144:159], a[36:39], a[140:143], v[144:159]
    v_mfma_f32_32x32x16_bf16 v[128:143], a[40:43], a[144:147], v[128:143]
    v_mfma_f32_32x32x16_bf16 v[144:159], a[40:43], a[148:151], v[144:159]
    buffer_load_dwordx4 v5, s[24:27], s60 offen offset:3072 nt lds
    s_waitcnt vmcnt(12)
    ds_read_b128 a[224:227], v19 offset:24576
    ds_read_b128 a[228:231], v20 offset:24576
    v_mfma_f32_32x32x16_bf16 v[128:143], a[44:47], a[152:155], v[128:143]
    ds_read_b128 a[232:235], v21 offset:24576
    ds_read_b128 a[236:239], v22 offset:24576
    v_mfma_f32_32x32x16_bf16 v[144:159], a[44:47], a[156:159], v[144:159]
    v_mfma_f32_32x32x16_bf16 v[128:143], a[48:51], a[160:163], v[128:143]
    s_add_u32 m0, s53, 8192
    s_add_u32 s60, s48, 33024
    buffer_load_dwordx4 v2, s[24:27], s60 offen nt lds
    v_mfma_f32_32x32x16_bf16 v[144:159], a[48:51], a[164:167], v[144:159]
    v_mfma_f32_32x32x16_bf16 v[128:143], a[52:55], a[168:171], v[128:143]
    v_mfma_f32_32x32x16_bf16 v[144:159], a[52:55], a[172:175], v[144:159]
    buffer_load_dwordx4 v3, s[24:27], s60 offen offset:1024 nt lds
    v_mfma_f32_32x32x16_bf16 v[128:143], a[56:59], a[176:179], v[128:143]
    s_waitcnt lgkmcnt(0)
    v_mfma_f32_32x32x16_bf16 v[144:159], a[56:59], a[180:183], v[144:159]
    v_mfma_f32_32x32x16_bf16 v[128:143], a[60:63], a[184:187], v[128:143]
    buffer_load_dwordx4 v4, s[24:27], s60 offen offset:2048 nt lds
    v_mfma_f32_32x32x16_bf16 v[144:159], a[60:63], a[188:191], v[144:159]
    v_mfma_f32_32x32x16_bf16 v[160:175], a[192:195], a[64:67], 0
    v_mfma_f32_32x32x16_bf16 v[176:191], a[192:195], a[68:71], 0
    buffer_load_dwordx4 v5, s[24:27], s60 offen offset:3072 nt lds
    s_waitcnt vmcnt(12)
    ds_read_b128 a[240:243], v19 offset:28672
    ds_read_b128 a[244:247], v20 offset:28672
    v_mfma_f32_32x32x16_bf16 v[160:175], a[196:199], a[72:75], v[160:175]
    ds_read_b128 a[248:251], v21 offset:28672
    ds_read_b128 a[252:255], v22 offset:28672
    s_nop 0
    v_max3_f32 v112, v128, v129, v130
    v_max_f32 v112, v112, v143
    v_max3_f32 v112, v112, v131, v132
    v_mfma_f32_32x32x16_bf16 v[176:191], a[196:199], a[76:79], v[176:191]
    v_max3_f32 v112, v112, v133, v134
    v_max3_f32 v112, v112, v135, v136
    v_max3_f32 v112, v112, v137, v138
    v_mfma_f32_32x32x16_bf16 v[160:175], a[200:203], a[80:83], v[160:175]
    v_max3_f32 v112, v112, v139, v140
    v_max3_f32 v112, v112, v141, v142
    v_max3_f32 v113, v144, v145, v146
    v_mfma_f32_32x32x16_bf16 v[176:191], a[200:203], a[84:87], v[176:191]
    s_add_u32 m0, s53, 12288
    s_add_u32 s60, s48, 33152
    buffer_load_dwordx4 v2, s[24:27], s60 offen nt lds
    v_max_f32 v113, v113, v159
    v_max3_f32 v113, v113, v147, v148
    v_max3_f32 v113, v113, v149, v150
    v_mfma_f32_32x32x16_bf16 v[160:175], a[204:207], a[88:91], v[160:175]
    v_max3_f32 v113, v113, v151, v152
    v_max3_f32 v113, v113, v153, v154
    v_max3_f32 v113, v113, v155, v156
    v_mfma_f32_32x32x16_bf16 v[176:191], a[204:207], a[92:95], v[176:191]
    s_waitcnt lgkmcnt(0)
    v_max3_f32 v113, v113, v157, v158
    v_mfma_f32_32x32x16_bf16 v[160:175], a[208:211], a[96:99], v[160:175]
    v_mfma_f32_32x32x16_bf16 v[176:191], a[208:211], a[100:103], v[176:191]
    buffer_load_dwordx4 v3, s[24:27], s60 offen offset:1024 nt lds
    v_mfma_f32_32x32x16_bf16 v[160:175], a[212:215], a[104:107], v[160:175]
    v_mfma_f32_32x32x16_bf16 v[176:191], a[212:215], a[108:111], v[176:191]
    v_mfma_f32_32x32x16_bf16 v[160:175], a[216:219], a[112:115], v[160:175]
    v_mfma_f32_32x32x16_bf16 v[176:191], a[216:219], a[116:119], v[176:191]
    buffer_load_dwordx4 v4, s[24:27], s60 offen offset:2048 nt lds
    v_mfma_f32_32x32x16_bf16 v[160:175], a[220:223], a[120:123], v[160:175]
    v_mfma_f32_32x32x16_bf16 v[176:191], a[220:223], a[124:127], v[176:191]
    v_mfma_f32_32x32x16_bf16 v[160:175], a[224:227], a[128:131], v[160:175]
    v_mfma_f32_32x32x16_bf16 v[176:191], a[224:227], a[132:135], v[176:191]
    buffer_load_dwordx4 v5, s[24:27], s60 offen offset:3072 nt lds
    s_waitcnt vmcnt(12)
    ds_read_b128 a[0:3], v19 offset:32768
    ds_read_b128 a[4:7], v20 offset:32768
    v_mfma_f32_32x32x16_bf16 v[160:175], a[228:231], a[136:139], v[160:175]
    ds_read_b128 a[8:11], v21 offset:32768
    ds_read_b128 a[12:15], v22 offset:32768
    v_mfma_f32_32x32x16_bf16 v[176:191], a[228:231], a[140:143], v[176:191]
    v_mfma_f32_32x32x16_bf16 v[160:175], a[232:235], a[144:147], v[160:175]
    v_mfma_f32_32x32x16_bf16 v[176:191], a[232:235], a[148:151], v[176:191]
    v_mfma_f32_32x32x16_bf16 v[160:175], a[236:239], a[152:155], v[160:175]
    s_add_u32 m0, s53, 16384
    s_add_u32 s60, s49, 49152
    buffer_load_dwordx4 v2, s[24:27], s60 offen nt lds
    v_mfma_f32_32x32x16_bf16 v[176:191], a[236:239], a[156:159], v[176:191]
    v_mfma_f32_32x32x16_bf16 v[160:175], a[240:243], a[160:163], v[160:175]
    s_waitcnt lgkmcnt(0)
    v_mfma_f32_32x32x16_bf16 v[176:191], a[240:243], a[164:167], v[176:191]
    v_mfma_f32_32x32x16_bf16 v[160:175], a[244:247], a[168:171], v[160:175]
    buffer_load_dwordx4 v3, s[24:27], s60 offen offset:1024 nt lds
    v_mfma_f32_32x32x16_bf16 v[176:191], a[244:247], a[172:175], v[176:191]
    v_mfma_f32_32x32x16_bf16 v[160:175], a[248:251], a[176:179], v[160:175]
    v_mfma_f32_32x32x16_bf16 v[176:191], a[248:251], a[180:183], v[176:191]
    v_mfma_f32_32x32x16_bf16 v[160:175], a[252:255], a[184:187], v[160:175]
    v_mfma_f32_32x32x16_bf16 v[176:191], a[252:255], a[188:191], v[176:191]
    buffer_load_dwordx4 v4, s[24:27], s60 offen offset:2048 nt lds
    v_mfma_f32_32x32x16_bf16 v[192:207], a[0:3], a[64:67], 0
    v_mfma_f32_32x32x16_bf16 v[208:223], a[0:3], a[68:71], 0
    v_mfma_f32_32x32x16_bf16 v[192:207], a[4:7], a[72:75], v[192:207]
    s_nop 6
    v_max3_f32 v112, v112, v160, v161
    v_max3_f32 v112, v112, v162, v163
    v_max3_f32 v112, v112, v164, v165
    v_mfma_f32_32x32x16_bf16 v[208:223], a[4:7], a[76:79], v[208:223]
    buffer_load_dwordx4 v5, s[24:27], s60 offen offset:3072 nt lds
    s_waitcnt vmcnt(12)
    ds_read_b128 a[16:19], v19 offset:36864
    ds_read_b128 a[20:23], v20 offset:36864
    v_max3_f32 v112, v112, v166, v167
    v_max3_f32 v112, v112, v168, v169
    v_max3_f32 v112, v112, v170, v171
    v_mfma_f32_32x32x16_bf16 v[192:207], a[8:11], a[80:83], v[192:207]
    ds_read_b128 a[24:27], v21 offset:36864
    ds_read_b128 a[28:31], v22 offset:36864
    v_max3_f32 v112, v112, v172, v173
    v_max3_f32 v112, v112, v174, v175
    v_max3_f32 v113, v113, v176, v177
    v_mfma_f32_32x32x16_bf16 v[208:223], a[8:11], a[84:87], v[208:223]
    v_max3_f32 v113, v113, v178, v179
    v_max3_f32 v113, v113, v180, v181
    v_max3_f32 v113, v113, v182, v183
    v_mfma_f32_32x32x16_bf16 v[192:207], a[12:15], a[88:91], v[192:207]
    v_max3_f32 v113, v113, v184, v185
    v_max3_f32 v113, v113, v186, v187
    v_max3_f32 v113, v113, v188, v189
    v_mfma_f32_32x32x16_bf16 v[208:223], a[12:15], a[92:95], v[208:223]
    s_add_u32 m0, s53, 20480
    s_add_u32 s60, s49, 49280
    buffer_load_dwordx4 v2, s[24:27], s60 offen nt lds
    v_max3_f32 v113, v113, v190, v191
    s_waitcnt lgkmcnt(3)
    v_mfma_f32_32x32x16_bf16 v[192:207], a[16:19], a[96:99], v[192:207]
    v_mfma_f32_32x32x16_bf16 v[208:223], a[16:19], a[100:103], v[208:223]
    s_waitcnt lgkmcnt(2)
    v_mfma_f32_32x32x16_bf16 v[192:207], a[20:23], a[104:107], v[192:207]
    s_waitcnt lgkmcnt(0)
    v_mfma_f32_32x32x16_bf16 v[208:223], a[20:23], a[108:111], v[208:223]
    buffer_load_dwordx4 v3, s[24:27], s60 offen offset:1024 nt lds
    v_mfma_f32_32x32x16_bf16 v[192:207], a[24:27], a[112:115], v[192:207]
    buffer_load_dwordx4 v4, s[24:27], s60 offen offset:2048 nt lds
    s_waitcnt vmcnt(11)
    ds_read_b128 a[32:35], v19 offset:8192
    ds_read_b128 a[36:39], v20 offset:8192
    ds_read_b128 a[40:43], v21 offset:8192
    ds_read_b128 a[44:47], v22 offset:8192
    v_mfma_f32_32x32x16_bf16 v[208:223], a[24:27], a[116:119], v[208:223]
    buffer_load_dwordx4 v5, s[24:27], s60 offen offset:3072 nt lds
    v_mfma_f32_32x32x16_bf16 v[192:207], a[28:31], a[120:123], v[192:207]
    v_mfma_f32_32x32x16_bf16 v[208:223], a[28:31], a[124:127], v[208:223]
    s_waitcnt lgkmcnt(3)
    v_mfma_f32_32x32x16_bf16 v[192:207], a[32:35], a[128:131], v[192:207]
    v_mfma_f32_32x32x16_bf16 v[208:223], a[32:35], a[132:135], v[208:223]
    s_add_u32 m0, s53, 24576
    s_add_u32 s60, s49, 49408
    buffer_load_dwordx4 v2, s[24:27], s60 offen nt lds
    s_waitcnt lgkmcnt(2)
    v_mfma_f32_32x32x16_bf16 v[192:207], a[36:39], a[136:139], v[192:207]
    s_waitcnt lgkmcnt(0)
    v_mfma_f32_32x32x16_bf16 v[208:223], a[36:39], a[140:143], v[208:223]
    v_mfma_f32_32x32x16_bf16 v[192:207], a[40:43], a[144:147], v[192:207]
    buffer_load_dwordx4 v3, s[24:27], s60 offen offset:1024 nt lds
    buffer_load_dwordx4 v4, s[24:27], s60 offen offset:2048 nt lds
    s_waitcnt vmcnt(11)
    ds_read_b128 a[48:51], v19 offset:12288
    ds_read_b128 a[52:55], v20 offset:12288
    ds_read_b128 a[56:59], v21 offset:12288
    ds_read_b128 a[60:63], v22 offset:12288
    v_mfma_f32_32x32x16_bf16 v[208:223], a[40:43], a[148:151], v[208:223]
    buffer_load_dwordx4 v5, s[24:27], s60 offen offset:3072 nt lds
    v_mfma_f32_32x32x16_bf16 v[192:207], a[44:47], a[152:155], v[192:207]
    v_mfma_f32_32x32x16_bf16 v[208:223], a[44:47], a[156:159], v[208:223]
    s_waitcnt lgkmcnt(3)
    v_mfma_f32_32x32x16_bf16 v[192:207], a[48:51], a[160:163], v[192:207]
    v_mfma_f32_32x32x16_bf16 v[208:223], a[48:51], a[164:167], v[208:223]
    s_add_u32 m0, s53, 28672
    s_add_u32 s60, s49, 49536
    buffer_load_dwordx4 v2, s[24:27], s60 offen nt lds
    s_waitcnt lgkmcnt(2)
    v_mfma_f32_32x32x16_bf16 v[192:207], a[52:55], a[168:171], v[192:207]
    s_waitcnt lgkmcnt(0)
    v_mfma_f32_32x32x16_bf16 v[208:223], a[52:55], a[172:175], v[208:223]
    v_mfma_f32_32x32x16_bf16 v[192:207], a[56:59], a[176:179], v[192:207]
    buffer_load_dwordx4 v3, s[24:27], s60 offen offset:1024 nt lds
    buffer_load_dwordx4 v4, s[24:27], s60 offen offset:2048 nt lds
    s_waitcnt vmcnt(11)
    ds_read_b128 a[192:195], v19 offset:16384
    ds_read_b128 a[196:199], v20 offset:16384
    ds_read_b128 a[200:203], v21 offset:16384
    ds_read_b128 a[204:207], v22 offset:16384
    v_mfma_f32_32x32x16_bf16 v[208:223], a[56:59], a[180:183], v[208:223]
    buffer_load_dwordx4 v5, s[24:27], s60 offen offset:3072 nt lds
    v_mfma_f32_32x32x16_bf16 v[192:207], a[60:63], a[184:187], v[192:207]
    v_mfma_f32_32x32x16_bf16 v[208:223], a[60:63], a[188:191], v[208:223]
    s_waitcnt lgkmcnt(3)
    v_mfma_f32_32x32x16_bf16 v[224:239], a[192:195], a[64:67], 0
    v_mfma_f32_32x32x16_bf16 v[240:255], a[192:195], a[68:71], 0
    s_add_u32 m0, s53, 32768
    s_add_u32 s60, s50, 0
    buffer_load_dwordx4 v6, s[28:31], s60 offen nt lds
    s_waitcnt lgkmcnt(2)
    v_mfma_f32_32x32x16_bf16 v[224:239], a[196:199], a[72:75], v[224:239]
    s_waitcnt lgkmcnt(0)
    s_nop 1
    v_max3_f32 v112, v112, v192, v193
    v_max3_f32 v112, v112, v194, v195
    v_max3_f32 v112, v112, v196, v197
    v_mfma_f32_32x32x16_bf16 v[240:255], a[196:199], a[76:79], v[240:255]
    v_max3_f32 v112, v112, v198, v199
    v_max3_f32 v112, v112, v200, v201
    v_max3_f32 v112, v112, v202, v203
    v_mfma_f32_32x32x16_bf16 v[224:239], a[200:203], a[80:83], v[224:239]
    v_max3_f32 v112, v112, v204, v205
    v_max3_f32 v112, v112, v206, v207
    v_max3_f32 v113, v113, v208, v209
    buffer_load_dwordx4 v7, s[28:31], s60 offen offset:1024 nt lds
    buffer_load_dwordx4 v8, s[28:31], s60 offen offset:2048 nt lds
    s_waitcnt vmcnt(11)
    ds_read_b128 a[208:211], v19 offset:20480
    ds_read_b128 a[212:215], v20 offset:20480
    ds_read_b128 a[216:219], v21 offset:20480
    ds_read_b128 a[220:223], v22 offset:20480
    v_mfma_f32_32x32x16_bf16 v[240:255], a[200:203], a[84:87], v[240:255]
    buffer_load_dwordx4 v9, s[28:31], s60 offen offset:3072 nt lds
    v_max3_f32 v113, v113, v210, v211
    v_max3_f32 v113, v113, v212, v213
    v_max3_f32 v113, v113, v214, v215
    v_mfma_f32_32x32x16_bf16 v[224:239], a[204:207], a[88:91], v[224:239]
    v_max3_f32 v113, v113, v216, v217
    v_max3_f32 v113, v113, v218, v219
    v_max3_f32 v113, v113, v220, v221
    v_mfma_f32_32x32x16_bf16 v[240:255], a[204:207], a[92:95], v[240:255]
    v_max3_f32 v113, v113, v222, v223
    s_waitcnt lgkmcnt(3)
    v_mfma_f32_32x32x16_bf16 v[224:239], a[208:211], a[96:99], v[224:239]
    v_mfma_f32_32x32x16_bf16 v[240:255], a[208:211], a[100:103], v[240:255]
    s_add_u32 m0, s53, 36864
    s_add_u32 s60, s50, 65536
    buffer_load_dwordx4 v6, s[28:31], s60 offen nt lds
    s_waitcnt lgkmcnt(2)
    v_mfma_f32_32x32x16_bf16 v[224:239], a[212:215], a[104:107], v[224:239]
    s_waitcnt lgkmcnt(0)
    v_mfma_f32_32x32x16_bf16 v[240:255], a[212:215], a[108:111], v[240:255]
    v_mfma_f32_32x32x16_bf16 v[224:239], a[216:219], a[112:115], v[224:239]
    buffer_load_dwordx4 v7, s[28:31], s60 offen offset:1024 nt lds
    buffer_load_dwordx4 v8, s[28:31], s60 offen offset:2048 nt lds
    s_waitcnt vmcnt(11)
    ds_read_b128 a[224:227], v19 offset:24576
    ds_read_b128 a[228:231], v20 offset:24576
    ds_read_b128 a[232:235], v21 offset:24576
    ds_read_b128 a[236:239], v22 offset:24576
    v_mfma_f32_32x32x16_bf16 v[240:255], a[216:219], a[116:119], v[240:255]
    buffer_load_dwordx4 v9, s[28:31], s60 offen offset:3072 nt lds
    v_mfma_f32_32x32x16_bf16 v[224:239], a[220:223], a[120:123], v[224:239]
    v_mfma_f32_32x32x16_bf16 v[240:255], a[220:223], a[124:127], v[240:255]
    s_waitcnt lgkmcnt(3)
    v_mfma_f32_32x32x16_bf16 v[224:239], a[224:227], a[128:131], v[224:239]
    v_mfma_f32_32x32x16_bf16 v[240:255], a[224:227], a[132:135], v[240:255]
    s_add_u32 m0, s53, 8192
    s_add_u32 s60, s50, 131072
    buffer_load_dwordx4 v6, s[28:31], s60 offen nt lds
    s_waitcnt lgkmcnt(2)
    v_mfma_f32_32x32x16_bf16 v[224:239], a[228:231], a[136:139], v[224:239]
    s_waitcnt lgkmcnt(0)
    v_mfma_f32_32x32x16_bf16 v[240:255], a[228:231], a[140:143], v[240:255]
    v_mfma_f32_32x32x16_bf16 v[224:239], a[232:235], a[144:147], v[224:239]
    buffer_load_dwordx4 v7, s[28:31], s60 offen offset:1024 nt lds
    buffer_load_dwordx4 v8, s[28:31], s60 offen offset:2048 nt lds
    s_waitcnt vmcnt(11)
    ds_read_b128 a[240:243], v19 offset:28672
    ds_read_b128 a[244:247], v20 offset:28672
    ds_read_b128 a[248:251], v21 offset:28672
    ds_read_b128 a[252:255], v22 offset:28672
    v_mfma_f32_32x32x16_bf16 v[240:255], a[232:235], a[148:151], v[240:255]
    buffer_load_dwordx4 v9, s[28:31], s60 offen offset:3072 nt lds
    v_mfma_f32_32x32x16_bf16 v[224:239], a[236:239], a[152:155], v[224:239]
    v_mfma_f32_32x32x16_bf16 v[240:255], a[236:239], a[156:159], v[240:255]
    s_waitcnt lgkmcnt(3)
    v_mfma_f32_32x32x16_bf16 v[224:239], a[240:243], a[160:163], v[224:239]
    v_mfma_f32_32x32x16_bf16 v[240:255], a[240:243], a[164:167], v[240:255]
    s_add_u32 m0, s53, 12288
    s_add_u32 s60, s50, 196608
    buffer_load_dwordx4 v6, s[28:31], s60 offen nt lds
    s_waitcnt lgkmcnt(2)
    v_mfma_f32_32x32x16_bf16 v[224:239], a[244:247], a[168:171], v[224:239]
    s_waitcnt lgkmcnt(0)
    v_mfma_f32_32x32x16_bf16 v[240:255], a[244:247], a[172:175], v[240:255]
    v_mfma_f32_32x32x16_bf16 v[224:239], a[248:251], a[176:179], v[224:239]
    v_mfma_f32_32x32x16_bf16 v[240:255], a[248:251], a[180:183], v[240:255]
    buffer_load_dwordx4 v7, s[28:31], s60 offen offset:1024 nt lds
    v_mfma_f32_32x32x16_bf16 v[224:239], a[252:255], a[184:187], v[224:239]
    v_mfma_f32_32x32x16_bf16 v[240:255], a[252:255], a[188:191], v[240:255]
    s_nop 10
    v_max3_f32 v112, v112, v224, v225
    v_max3_f32 v112, v112, v226, v227
    v_max3_f32 v112, v112, v228, v229
    v_max3_f32 v112, v112, v230, v231
    v_max3_f32 v112, v112, v232, v233
    v_max3_f32 v112, v112, v234, v235
    v_max3_f32 v112, v112, v236, v237
    v_max3_f32 v112, v112, v238, v239
    v_max3_f32 v113, v113, v240, v241
    v_max3_f32 v113, v113, v242, v243
    v_max3_f32 v113, v113, v244, v245
    v_max3_f32 v113, v113, v246, v247
    v_max3_f32 v113, v113, v248, v249
    v_max3_f32 v113, v113, v250, v251
    v_max3_f32 v113, v113, v252, v253
    v_max3_f32 v113, v113, v254, v255
    buffer_load_dwordx4 v8, s[28:31], s60 offen offset:2048 nt lds
    s_nop 0
    v_permlane32_swap_b32 v112, v113
    v_max_f32 v112, v112, v113
    ds_write_b32 v31, v112 offset:24576
    v_and_b32 v108, 31, v0
    v_lshlrev_b32 v108, 2, v108
    v_add_u32 v111, 122880, v108
    v_add_u32 v110, 81920, v108
    v_add_u32 v109, 40960, v108
    s_waitcnt lgkmcnt(0)
    s_barrier
    ds_read_b32 v96, v108 offset:24576
    ds_read_b32 v97, v108 offset:24704
    ds_read_b32 v98, v109 offset:24576
    ds_read_b32 v99, v109 offset:24704
    ds_read_b32 v100, v110 offset:24576
    ds_read_b32 v101, v110 offset:24704
    ds_read_b32 v102, v111 offset:24576
    ds_read_b32 v103, v111 offset:24704
    s_waitcnt lgkmcnt(3)
    v_max3_f32 v114, v96, v98, v100
    buffer_load_dwordx4 v9, s[28:31], s60 offen offset:3072 nt lds
    s_waitcnt vmcnt(12)
    ds_read_b64_tr_b16 a[0:1], v25 offset:32768
    s_waitcnt lgkmcnt(2)
    v_max_f32 v114, v114, v102
    ds_read_b64_tr_b16 a[2:3], v25 offset:33792
    v_mul_f32 v114, s58, v114
    ds_read_b64_tr_b16 a[4:5], v26 offset:32768
    v_sub_f32 v114, 0, v114
    ds_read_b64_tr_b16 a[6:7], v26 offset:33792
    v_max3_f32 v115, v97, v99, v101
    ds_read_b64_tr_b16 a[8:9], v25 offset:34816
    s_waitcnt lgkmcnt(5)
    v_max_f32 v115, v115, v103
    ds_read_b64_tr_b16 a[10:11], v25 offset:35840
    v_mul_f32 v115, s58, v115
    ds_read_b64_tr_b16 a[12:13], v26 offset:34816
    v_sub_f32 v115, 0, v115
    ds_read_b64_tr_b16 a[14:15], v26 offset:35840
    v_fma_f32 v128, v128, s58, v114
    v_fma_f32 v129, v129, s58, v114
    v_fma_f32 v130, v130, s58, v114
    v_fma_f32 v131, v131, s58, v114
    v_fma_f32 v132, v132, s58, v114
    s_add_u32 m0, s53, 28672
    s_add_u32 s60, s51, 16384
    buffer_load_dwordx4 v6, s[28:31], s60 offen nt lds
    v_fma_f32 v133, v133, s58, v114
    v_fma_f32 v134, v134, s58, v114
    v_fma_f32 v135, v135, s58, v114
    v_exp_f32 v128, v128
    v_exp_f32 v129, v129
    v_exp_f32 v130, v130
    v_exp_f32 v131, v131
    v_exp_f32 v132, v132
    v_exp_f32 v133, v133
    v_exp_f32 v134, v134
    v_exp_f32 v135, v135
    v_mov_b32 v104, v128
    v_mov_b32 v105, v129
    v_cvt_pk_bf16_f32 v128, v128, v129
    v_add_f32 v104, v104, v130
    v_add_f32 v105, v105, v131
    v_cvt_pk_bf16_f32 v129, v130, v131
    v_add_f32 v104, v104, v132
    v_add_f32 v105, v105, v133
    s_waitcnt lgkmcnt(0)
    buffer_load_dwordx4 v7, s[28:31], s60 offen offset:1024 nt lds
    v_cvt_pk_bf16_f32 v130, v132, v133
    v_add_f32 v104, v104, v134
    v_add_f32 v105, v105, v135
    v_cvt_pk_bf16_f32 v131, v134, v135
    ds_write_b128 v27, v[128:131] offset:16384
    v_fma_f32 v144, v144, s58, v115
    v_fma_f32 v145, v145, s58, v115
    v_fma_f32 v146, v146, s58, v115
    v_fma_f32 v147, v147, s58, v115
    v_fma_f32 v148, v148, s58, v115
    v_fma_f32 v149, v149, s58, v115
    v_fma_f32 v150, v150, s58, v115
    v_fma_f32 v151, v151, s58, v115
    v_exp_f32 v144, v144
    v_exp_f32 v145, v145
    v_exp_f32 v146, v146
    v_exp_f32 v147, v147
    v_exp_f32 v148, v148
    v_exp_f32 v149, v149
    v_exp_f32 v150, v150
    buffer_load_dwordx4 v8, s[28:31], s60 offen offset:2048 nt lds
    v_exp_f32 v151, v151
    v_mov_b32 v106, v144
    v_mov_b32 v107, v145
    v_cvt_pk_bf16_f32 v144, v144, v145
    v_add_f32 v106, v106, v146
    v_add_f32 v107, v107, v147
    v_cvt_pk_bf16_f32 v145, v146, v147
    v_add_f32 v106, v106, v148
    v_add_f32 v107, v107, v149
    v_cvt_pk_bf16_f32 v146, v148, v149
    v_add_f32 v106, v106, v150
    v_add_f32 v107, v107, v151
    v_cvt_pk_bf16_f32 v147, v150, v151
    ds_write_b128 v27, v[144:147] offset:17408
    v_fma_f32 v136, v136, s58, v114
    v_fma_f32 v137, v137, s58, v114
    v_fma_f32 v138, v138, s58, v114
    v_fma_f32 v139, v139, s58, v114
    v_fma_f32 v140, v140, s58, v114
    v_fma_f32 v141, v141, s58, v114
    v_fma_f32 v142, v142, s58, v114
    v_fma_f32 v143, v143, s58, v114
    v_exp_f32 v136, v136
    buffer_load_dwordx4 v9, s[28:31], s60 offen offset:3072 nt lds
    s_waitcnt vmcnt(12)
    ds_read_b64_tr_b16 a[16:17], v25 offset:36864
    v_exp_f32 v137, v137
    ds_read_b64_tr_b16 a[18:19], v25 offset:37888
    v_exp_f32 v138, v138
    ds_read_b64_tr_b16 a[20:21], v26 offset:36864
    v_exp_f32 v139, v139
    ds_read_b64_tr_b16 a[22:23], v26 offset:37888
    v_exp_f32 v140, v140
    ds_read_b64_tr_b16 a[24:25], v25 offset:38912
    v_exp_f32 v141, v141
    ds_read_b64_tr_b16 a[26:27], v25 offset:39936
    v_exp_f32 v142, v142
    ds_read_b64_tr_b16 a[28:29], v26 offset:38912
    v_exp_f32 v143, v143
    ds_read_b64_tr_b16 a[30:31], v26 offset:39936
    v_add_f32 v104, v104, v136
    v_add_f32 v105, v105, v137
    v_cvt_pk_bf16_f32 v136, v136, v137
    v_add_f32 v104, v104, v138
    v_add_f32 v105, v105, v139
    v_cvt_pk_bf16_f32 v137, v138, v139
    v_add_f32 v104, v104, v140
    v_add_f32 v105, v105, v141
    s_add_u32 m0, s53, 32768
    s_add_u32 s60, s51, 81920
    buffer_load_dwordx4 v6, s[28:31], s60 offen nt lds
    v_cvt_pk_bf16_f32 v138, v140, v141
    v_add_f32 v104, v104, v142
    v_add_f32 v105, v105, v143
    v_cvt_pk_bf16_f32 v139, v142, v143
    ds_write_b128 v27, v[136:139] offset:18432
    v_fma_f32 v152, v152, s58, v115
    v_fma_f32 v153, v153, s58, v115
    v_fma_f32 v154, v154, s58, v115
    v_fma_f32 v155, v155, s58, v115
    v_fma_f32 v156, v156, s58, v115
    v_fma_f32 v157, v157, s58, v115
    v_fma_f32 v158, v158, s58, v115
    v_fma_f32 v159, v159, s58, v115
    v_exp_f32 v152, v152
    v_exp_f32 v153, v153
    v_exp_f32 v154, v154
    v_exp_f32 v155, v155
    s_waitcnt lgkmcnt(1)
    v_exp_f32 v156, v156
    v_exp_f32 v157, v157
    buffer_load_dwordx4 v7, s[28:31], s60 offen offset:1024 nt lds
    v_exp_f32 v158, v158
    v_exp_f32 v159, v159
    v_add_f32 v106, v106, v152
    v_add_f32 v107, v107, v153
    v_cvt_pk_bf16_f32 v152, v152, v153
    v_add_f32 v106, v106, v154
    v_add_f32 v107, v107, v155
    v_cvt_pk_bf16_f32 v153, v154, v155
    v_add_f32 v106, v106, v156
    v_add_f32 v107, v107, v157
    v_cvt_pk_bf16_f32 v154, v156, v157
    v_add_f32 v106, v106, v158
    v_add_f32 v107, v107, v159
    v_cvt_pk_bf16_f32 v155, v158, v159
    ds_write_b128 v27, v[152:155] offset:19456
    s_waitcnt lgkmcnt(0)
    s_barrier
    ds_read_b128 v[32:35], v28 offset:16384
    buffer_load_dwordx4 v8, s[28:31], s60 offen offset:2048 nt lds
    ds_read_b128 v[36:39], v28 offset:17408
    ds_read_b128 v[40:43], v28 offset:18432
    ds_read_b128 v[44:47], v28 offset:19456
    s_waitcnt lgkmcnt(3)
    v_mfma_f32_32x32x16_bf16 v[64:79], a[0:3], v[32:35], 0
    v_fma_f32 v160, v160, s58, v114
    v_fma_f32 v161, v161, s58, v114
    v_fma_f32 v162, v162, s58, v114
    v_fma_f32 v163, v163, s58, v114
    v_fma_f32 v164, v164, s58, v114
    ds_read_b128 v[48:51], v28 offset:57344
    s_waitcnt lgkmcnt(3)
    v_mfma_f32_32x32x16_bf16 v[80:95], a[0:3], v[36:39], 0
    v_fma_f32 v165, v165, s58, v114
    v_fma_f32 v166, v166, s58, v114
    v_fma_f32 v167, v167, s58, v114
    v_exp_f32 v160, v160
    v_exp_f32 v161, v161
    ds_read_b128 v[52:55], v28 offset:58368
    v_mfma_f32_32x32x16_bf16 v[128:143], a[4:7], v[32:35], 0
    buffer_load_dwordx4 v9, s[28:31], s60 offen offset:3072 nt lds
    s_waitcnt vmcnt(12)
    ds_read_b64_tr_b16 a[32:33], v25 offset:8192
    ds_read_b64_tr_b16 a[34:35], v25 offset:9216
    v_exp_f32 v162, v162
    v_exp_f32 v163, v163
    v_exp_f32 v164, v164
    v_exp_f32 v165, v165
    v_exp_f32 v166, v166
    ds_read_b128 v[56:59], v28 offset:59392
    v_mfma_f32_32x32x16_bf16 v[144:159], a[4:7], v[36:39], 0
    ds_read_b64_tr_b16 a[36:37], v26 offset:8192
    ds_read_b64_tr_b16 a[38:39], v26 offset:9216
    v_exp_f32 v167, v167
    v_add_f32 v104, v104, v160
    v_add_f32 v105, v105, v161
    v_cvt_pk_bf16_f32 v160, v160, v161
    v_add_f32 v104, v104, v162
    ds_read_b128 v[60:63], v28 offset:60416
    s_waitcnt lgkmcnt(9)
    v_mfma_f32_32x32x16_bf16 v[64:79], a[8:11], v[40:43], v[64:79]
    ds_read_b64_tr_b16 a[40:41], v25 offset:10240
    ds_read_b64_tr_b16 a[42:43], v25 offset:11264
    v_add_f32 v105, v105, v163
    v_cvt_pk_bf16_f32 v161, v162, v163
    v_add_f32 v104, v104, v164
    v_add_f32 v105, v105, v165
    v_cvt_pk_bf16_f32 v162, v164, v165
    ds_read_b64_tr_b16 a[44:45], v26 offset:10240
    ds_read_b64_tr_b16 a[46:47], v26 offset:11264
    s_waitcnt lgkmcnt(12)
    v_mfma_f32_32x32x16_bf16 v[80:95], a[8:11], v[44:47], v[80:95]
    s_add_u32 m0, s53, 36864
    s_add_u32 s60, s51, 147456
    buffer_load_dwordx4 v6, s[28:31], s60 offen nt lds
    v_add_f32 v104, v104, v166
    v_add_f32 v105, v105, v167
    v_cvt_pk_bf16_f32 v163, v166, v167
    ds_write_b128 v27, v[160:163] offset:20480
    v_fma_f32 v176, v176, s58, v115
    v_mfma_f32_32x32x16_bf16 v[128:143], a[12:15], v[40:43], v[128:143]
    v_fma_f32 v177, v177, s58, v115
    v_fma_f32 v178, v178, s58, v115
    v_fma_f32 v179, v179, s58, v115
    v_fma_f32 v180, v180, s58, v115
    v_fma_f32 v181, v181, s58, v115
    v_mfma_f32_32x32x16_bf16 v[144:159], a[12:15], v[44:47], v[144:159]
    buffer_load_dwordx4 v7, s[28:31], s60 offen offset:1024 nt lds
    v_fma_f32 v182, v182, s58, v115
    v_fma_f32 v183, v183, s58, v115
    v_exp_f32 v176, v176
    v_exp_f32 v177, v177
    v_exp_f32 v178, v178
    s_waitcnt lgkmcnt(12)
    v_mfma_f32_32x32x16_bf16 v[64:79], a[16:19], v[48:51], v[64:79]
    v_exp_f32 v179, v179
    v_exp_f32 v180, v180
    v_exp_f32 v181, v181
    v_exp_f32 v182, v182
    v_exp_f32 v183, v183
    ds_read_b128 v[32:35], v29 offset:32768
    s_waitcnt lgkmcnt(12)
    v_mfma_f32_32x32x16_bf16 v[80:95], a[16:19], v[52:55], v[80:95]
    s_waitcnt lgkmcnt(2)
    v_add_f32 v106, v106, v176
    v_add_f32 v107, v107, v177
    v_cvt_pk_bf16_f32 v176, v176, v177
    v_add_f32 v106, v106, v178
    v_add_f32 v107, v107, v179
    ds_read_b128 v[36:39], v29 offset:33792
    v_mfma_f32_32x32x16_bf16 v[128:143], a[20:23], v[48:51], v[128:143]
    buffer_load_dwordx4 v8, s[28:31], s60 offen offset:2048 nt lds
    v_cvt_pk_bf16_f32 v177, v178, v179
    v_add_f32 v106, v106, v180
    v_add_f32 v107, v107, v181
    v_cvt_pk_bf16_f32 v178, v180, v181
    v_add_f32 v106, v106, v182
    ds_read_b128 v[40:43], v29 offset:34816
    v_mfma_f32_32x32x16_bf16 v[144:159], a[20:23], v[52:55], v[144:159]
    v_add_f32 v107, v107, v183
    v_cvt_pk_bf16_f32 v179, v182, v183
    ds_write_b128 v27, v[176:179] offset:21504
    v_fma_f32 v168, v168, s58, v114
    v_fma_f32 v169, v169, s58, v114
    ds_read_b128 v[44:47], v29 offset:35840
    v_mfma_f32_32x32x16_bf16 v[64:79], a[24:27], v[56:59], v[64:79]
    v_fma_f32 v170, v170, s58, v114
    v_fma_f32 v171, v171, s58, v114
    v_fma_f32 v172, v172, s58, v114
    v_fma_f32 v173, v173, s58, v114
    v_fma_f32 v174, v174, s58, v114
    v_mfma_f32_32x32x16_bf16 v[80:95], a[24:27], v[60:63], v[80:95]
    v_fma_f32 v175, v175, s58, v114
    v_exp_f32 v168, v168
    v_exp_f32 v169, v169
    v_exp_f32 v170, v170
    v_exp_f32 v171, v171
    v_mfma_f32_32x32x16_bf16 v[128:143], a[28:31], v[56:59], v[128:143]
    buffer_load_dwordx4 v9, s[28:31], s60 offen offset:3072 nt lds
    s_waitcnt vmcnt(12)
    ds_read_b64_tr_b16 a[48:49], v25 offset:12288
    ds_read_b64_tr_b16 a[50:51], v25 offset:13312
    v_exp_f32 v172, v172
    v_exp_f32 v173, v173
    v_exp_f32 v174, v174
    v_exp_f32 v175, v175
    v_add_f32 v104, v104, v168
    v_mfma_f32_32x32x16_bf16 v[144:159], a[28:31], v[60:63], v[144:159]
    ds_read_b64_tr_b16 a[52:53], v26 offset:12288
    ds_read_b64_tr_b16 a[54:55], v26 offset:13312
    v_add_f32 v105, v105, v169
    v_cvt_pk_bf16_f32 v168, v168, v169
    v_add_f32 v104, v104, v170
    v_add_f32 v105, v105, v171
    v_cvt_pk_bf16_f32 v169, v170, v171
    s_waitcnt lgkmcnt(8)
    v_mfma_f32_32x32x16_bf16 v[64:79], a[32:35], v[32:35], v[64:79]
    s_add_u32 m0, s53, 24576
    s_add_u32 s60, s51, 212992
    buffer_load_dwordx4 v6, s[28:31], s60 offen nt lds
    ds_read_b64_tr_b16 a[56:57], v25 offset:14336
    ds_read_b64_tr_b16 a[58:59], v25 offset:15360
    v_add_f32 v104, v104, v172
    v_add_f32 v105, v105, v173
    v_cvt_pk_bf16_f32 v170, v172, v173
    v_add_f32 v104, v104, v174
    v_add_f32 v105, v105, v175
    ds_read_b128 v[48:51], v30 offset:8192
    s_waitcnt lgkmcnt(10)
    v_mfma_f32_32x32x16_bf16 v[80:95], a[32:35], v[36:39], v[80:95]
    ds_read_b64_tr_b16 a[60:61], v26 offset:14336
    ds_read_b64_tr_b16 a[62:63], v26 offset:15360
    v_cvt_pk_bf16_f32 v171, v174, v175
    ds_write_b128 v27, v[168:171] offset:22528
    v_fma_f32 v184, v184, s58, v115
    v_fma_f32 v185, v185, s58, v115
    v_fma_f32 v186, v186, s58, v115
    ds_read_b128 v[52:55], v30 offset:9216
    v_mfma_f32_32x32x16_bf16 v[128:143], a[36:39], v[32:35], v[128:143]
    v_fma_f32 v187, v187, s58, v115
    v_fma_f32 v188, v188, s58, v115
    v_fma_f32 v189, v189, s58, v115
    v_fma_f32 v190, v190, s58, v115
    v_fma_f32 v191, v191, s58, v115
    ds_read_b128 v[56:59], v30 offset:10240
    v_mfma_f32_32x32x16_bf16 v[144:159], a[36:39], v[36:39], v[144:159]
    buffer_load_dwordx4 v7, s[28:31], s60 offen offset:1024 nt lds
    v_exp_f32 v184, v184
    v_exp_f32 v185, v185
    v_exp_f32 v186, v186
    v_exp_f32 v187, v187
    v_exp_f32 v188, v188
    ds_read_b128 v[60:63], v30 offset:11264
    s_waitcnt lgkmcnt(14)
    v_mfma_f32_32x32x16_bf16 v[64:79], a[40:43], v[40:43], v[64:79]
    v_exp_f32 v189, v189
    v_exp_f32 v190, v190
    v_exp_f32 v191, v191
    v_add_f32 v106, v106, v184
    v_add_f32 v107, v107, v185
    s_waitcnt lgkmcnt(13)
    v_mfma_f32_32x32x16_bf16 v[80:95], a[40:43], v[44:47], v[80:95]
    s_waitcnt lgkmcnt(4)
    v_cvt_pk_bf16_f32 v184, v184, v185
    v_add_f32 v106, v106, v186
    v_add_f32 v107, v107, v187
    v_cvt_pk_bf16_f32 v185, v186, v187
    v_add_f32 v106, v106, v188
    v_mfma_f32_32x32x16_bf16 v[128:143], a[44:47], v[40:43], v[128:143]
    buffer_load_dwordx4 v8, s[28:31], s60 offen offset:2048 nt lds
    v_add_f32 v107, v107, v189
    v_cvt_pk_bf16_f32 v186, v188, v189
    v_add_f32 v106, v106, v190
    v_add_f32 v107, v107, v191
    v_cvt_pk_bf16_f32 v187, v190, v191
    v_mfma_f32_32x32x16_bf16 v[144:159], a[44:47], v[44:47], v[144:159]
    ds_write_b128 v27, v[184:187] offset:23552
    v_mfma_f32_32x32x16_bf16 v[64:79], a[48:51], v[48:51], v[64:79]
    s_waitcnt lgkmcnt(0)
    s_barrier
    ds_read_b128 v[32:35], v28 offset:20480
    v_mfma_f32_32x32x16_bf16 v[80:95], a[48:51], v[52:55], v[80:95]
    buffer_load_dwordx4 v9, s[28:31], s60 offen offset:3072 nt lds
    s_waitcnt vmcnt(12)
    ds_read_b64_tr_b16 a[192:193], v25 offset:28672
    ds_read_b64_tr_b16 a[194:195], v25 offset:29696
    ds_read_b128 v[36:39], v28 offset:21504
    v_mfma_f32_32x32x16_bf16 v[128:143], a[52:55], v[48:51], v[128:143]
    ds_read_b64_tr_b16 a[196:197], v26 offset:28672
    ds_read_b64_tr_b16 a[198:199], v26 offset:29696
    ds_read_b128 v[40:43], v28 offset:22528
    v_mfma_f32_32x32x16_bf16 v[144:159], a[52:55], v[52:55], v[144:159]
    ds_read_b64_tr_b16 a[200:201], v25 offset:30720
    ds_read_b64_tr_b16 a[202:203], v25 offset:31744
    ds_read_b128 v[44:47], v28 offset:23552
    v_mfma_f32_32x32x16_bf16 v[64:79], a[56:59], v[56:59], v[64:79]
    ds_read_b64_tr_b16 a[204:205], v26 offset:30720
    ds_read_b64_tr_b16 a[206:207], v26 offset:31744
    v_mfma_f32_32x32x16_bf16 v[80:95], a[56:59], v[60:63], v[80:95]
    s_add_u32 m0, s53, 8192
    s_add_u32 s60, s50, 32768
    buffer_load_dwordx4 v6, s[28:31], s60 offen nt lds
    v_mfma_f32_32x32x16_bf16 v[128:143], a[60:63], v[56:59], v[128:143]
    v_mfma_f32_32x32x16_bf16 v[144:159], a[60:63], v[60:63], v[144:159]
    s_waitcnt lgkmcnt(9)
    v_mfma_f32_32x32x16_bf16 v[64:79], a[192:195], v[32:35], v[64:79]
    v_fma_f32 v192, v192, s58, v114
    v_fma_f32 v193, v193, s58, v114
    v_fma_f32 v194, v194, s58, v114
    v_fma_f32 v195, v195, s58, v114
    v_fma_f32 v196, v196, s58, v114
    ds_read_b128 v[48:51], v28 offset:61440
    s_waitcnt lgkmcnt(9)
    v_mfma_f32_32x32x16_bf16 v[80:95], a[192:195], v[36:39], v[80:95]
    buffer_load_dwordx4 v7, s[28:31], s60 offen offset:1024 nt lds
    v_fma_f32 v197, v197, s58, v114
    v_fma_f32 v198, v198, s58, v114
    v_fma_f32 v199, v199, s58, v114
    v_exp_f32 v192, v192
    v_exp_f32 v193, v193
    ds_read_b128 v[52:55], v28 offset:62464
    s_waitcnt lgkmcnt(8)
    v_mfma_f32_32x32x16_bf16 v[128:143], a[196:199], v[32:35], v[128:143]
    s_waitcnt lgkmcnt(2)
    v_exp_f32 v194, v194
    v_exp_f32 v195, v195
    v_exp_f32 v196, v196
    v_exp_f32 v197, v197
    v_exp_f32 v198, v198
    ds_read_b128 v[56:59], v28 offset:63488
    v_mfma_f32_32x32x16_bf16 v[144:159], a[196:199], v[36:39], v[144:159]
    v_exp_f32 v199, v199
    v_add_f32 v104, v104, v192
    v_add_f32 v105, v105, v193
    v_cvt_pk_bf16_f32 v192, v192, v193
    v_add_f32 v104, v104, v194
    ds_read_b128 v[60:63], v28 offset:64512
    v_mfma_f32_32x32x16_bf16 v[64:79], a[200:203], v[40:43], v[64:79]
    buffer_load_dwordx4 v8, s[28:31], s60 offen offset:2048 nt lds
    v_add_f32 v105, v105, v195
    v_cvt_pk_bf16_f32 v193, v194, v195
    v_add_f32 v104, v104, v196
    v_add_f32 v105, v105, v197
    v_cvt_pk_bf16_f32 v194, v196, v197
    s_waitcnt vmcnt(11)
    ds_read_b64_tr_b16 a[208:209], v25 offset:32768
    ds_read_b64_tr_b16 a[210:211], v25 offset:33792
    ds_read_b64_tr_b16 a[212:213], v26 offset:32768
    ds_read_b64_tr_b16 a[214:215], v26 offset:33792
    ds_read_b64_tr_b16 a[216:217], v25 offset:34816
    ds_read_b64_tr_b16 a[218:219], v25 offset:35840
    ds_read_b64_tr_b16 a[220:221], v26 offset:34816
    ds_read_b64_tr_b16 a[222:223], v26 offset:35840
    v_mfma_f32_32x32x16_bf16 v[80:95], a[200:203], v[44:47], v[80:95]
    buffer_load_dwordx4 v9, s[28:31], s60 offen offset:3072 nt lds
    v_add_f32 v104, v104, v198
    v_add_f32 v105, v105, v199
    v_cvt_pk_bf16_f32 v195, v198, v199
    ds_write_b128 v27, v[192:195] offset:0
    v_fma_f32 v208, v208, s58, v115
    v_mfma_f32_32x32x16_bf16 v[128:143], a[204:207], v[40:43], v[128:143]
    v_fma_f32 v209, v209, s58, v115
    v_fma_f32 v210, v210, s58, v115
    v_fma_f32 v211, v211, s58, v115
    v_fma_f32 v212, v212, s58, v115
    v_fma_f32 v213, v213, s58, v115
    v_mfma_f32_32x32x16_bf16 v[144:159], a[204:207], v[44:47], v[144:159]
    v_fma_f32 v214, v214, s58, v115
    v_fma_f32 v215, v215, s58, v115
    v_exp_f32 v208, v208
    v_exp_f32 v209, v209
    v_exp_f32 v210, v210
    s_waitcnt lgkmcnt(7)
    v_mfma_f32_32x32x16_bf16 v[64:79], a[208:211], v[48:51], v[64:79]
    s_add_u32 m0, s53, 12288
    s_add_u32 s60, s50, 98304
    buffer_load_dwordx4 v6, s[28:31], s60 offen nt lds
    v_exp_f32 v211, v211
    v_exp_f32 v212, v212
    v_exp_f32 v213, v213
    v_exp_f32 v214, v214
    v_exp_f32 v215, v215
    ds_read_b128 v[32:35], v29 offset:36864
    v_mfma_f32_32x32x16_bf16 v[80:95], a[208:211], v[52:55], v[80:95]
    s_waitcnt lgkmcnt(2)
    v_add_f32 v106, v106, v208
    v_add_f32 v107, v107, v209
    v_cvt_pk_bf16_f32 v208, v208, v209
    v_add_f32 v106, v106, v210
    v_add_f32 v107, v107, v211
    ds_read_b128 v[36:39], v29 offset:37888
    v_mfma_f32_32x32x16_bf16 v[128:143], a[212:215], v[48:51], v[128:143]
    v_cvt_pk_bf16_f32 v209, v210, v211
    v_add_f32 v106, v106, v212
    v_add_f32 v107, v107, v213
    v_cvt_pk_bf16_f32 v210, v212, v213
    v_add_f32 v106, v106, v214
    ds_read_b128 v[40:43], v29 offset:38912
    v_mfma_f32_32x32x16_bf16 v[144:159], a[212:215], v[52:55], v[144:159]
    buffer_load_dwordx4 v7, s[28:31], s60 offen offset:1024 nt lds
    v_add_f32 v107, v107, v215
    v_cvt_pk_bf16_f32 v211, v214, v215
    ds_write_b128 v27, v[208:211] offset:1024
    v_fma_f32 v200, v200, s58, v114
    v_fma_f32 v201, v201, s58, v114
    ds_read_b128 v[44:47], v29 offset:39936
    v_mfma_f32_32x32x16_bf16 v[64:79], a[216:219], v[56:59], v[64:79]
    v_fma_f32 v202, v202, s58, v114
    v_fma_f32 v203, v203, s58, v114
    v_fma_f32 v204, v204, s58, v114
    v_fma_f32 v205, v205, s58, v114
    v_fma_f32 v206, v206, s58, v114
    buffer_load_dwordx4 v8, s[28:31], s60 offen offset:2048 nt lds
    s_waitcnt vmcnt(11)
    ds_read_b64_tr_b16 a[224:225], v25 offset:36864
    ds_read_b64_tr_b16 a[226:227], v25 offset:37888
    ds_read_b64_tr_b16 a[228:229], v26 offset:36864
    ds_read_b64_tr_b16 a[230:231], v26 offset:37888
    ds_read_b64_tr_b16 a[232:233], v25 offset:38912
    ds_read_b64_tr_b16 a[234:235], v25 offset:39936
    ds_read_b64_tr_b16 a[236:237], v26 offset:38912
    ds_read_b64_tr_b16 a[238:239], v26 offset:39936
    v_mfma_f32_32x32x16_bf16 v[80:95], a[216:219], v[60:63], v[80:95]
    buffer_load_dwordx4 v9, s[28:31], s60 offen offset:3072 nt lds
    v_fma_f32 v207, v207, s58, v114
    v_exp_f32 v200, v200
    v_exp_f32 v201, v201
    v_exp_f32 v202, v202
    v_exp_f32 v203, v203
    v_mfma_f32_32x32x16_bf16 v[128:143], a[220:223], v[56:59], v[128:143]
    v_exp_f32 v204, v204
    v_exp_f32 v205, v205
    v_exp_f32 v206, v206
    v_exp_f32 v207, v207
    v_add_f32 v104, v104, v200
    v_mfma_f32_32x32x16_bf16 v[144:159], a[220:223], v[60:63], v[144:159]
    s_add_u32 m0, s53, 28672
    s_add_u32 s60, s50, 163840
    buffer_load_dwordx4 v6, s[28:31], s60 offen nt lds
    v_add_f32 v105, v105, v201
    v_cvt_pk_bf16_f32 v200, v200, v201
    v_add_f32 v104, v104, v202
    v_add_f32 v105, v105, v203
    v_cvt_pk_bf16_f32 v201, v202, v203
    s_waitcnt lgkmcnt(6)
    v_mfma_f32_32x32x16_bf16 v[64:79], a[224:227], v[32:35], v[64:79]
    s_waitcnt lgkmcnt(0)
    v_add_f32 v104, v104, v204
    v_add_f32 v105, v105, v205
    v_cvt_pk_bf16_f32 v202, v204, v205
    v_add_f32 v104, v104, v206
    v_add_f32 v105, v105, v207
    ds_read_b128 v[48:51], v30 offset:12288
    v_mfma_f32_32x32x16_bf16 v[80:95], a[224:227], v[36:39], v[80:95]
    v_cvt_pk_bf16_f32 v203, v206, v207
    ds_write_b128 v27, v[200:203] offset:2048
    v_fma_f32 v216, v216, s58, v115
    v_fma_f32 v217, v217, s58, v115
    v_fma_f32 v218, v218, s58, v115
    ds_read_b128 v[52:55], v30 offset:13312
    v_mfma_f32_32x32x16_bf16 v[128:143], a[228:231], v[32:35], v[128:143]
    v_fma_f32 v219, v219, s58, v115
    v_fma_f32 v220, v220, s58, v115
    v_fma_f32 v221, v221, s58, v115
    v_fma_f32 v222, v222, s58, v115
    v_fma_f32 v223, v223, s58, v115
    ds_read_b128 v[56:59], v30 offset:14336
    v_mfma_f32_32x32x16_bf16 v[144:159], a[228:231], v[36:39], v[144:159]
    buffer_load_dwordx4 v7, s[28:31], s60 offen offset:1024 nt lds
    v_exp_f32 v216, v216
    v_exp_f32 v217, v217
    v_exp_f32 v218, v218
    v_exp_f32 v219, v219
    v_exp_f32 v220, v220
    ds_read_b128 v[60:63], v30 offset:15360
    v_mfma_f32_32x32x16_bf16 v[64:79], a[232:235], v[40:43], v[64:79]
    v_exp_f32 v221, v221
    v_exp_f32 v222, v222
    v_exp_f32 v223, v223
    v_add_f32 v106, v106, v216
    v_add_f32 v107, v107, v217
    buffer_load_dwordx4 v8, s[28:31], s60 offen offset:2048 nt lds
    s_waitcnt vmcnt(11)
    ds_read_b64_tr_b16 a[240:241], v25 offset:24576
    ds_read_b64_tr_b16 a[242:243], v25 offset:25600
    ds_read_b64_tr_b16 a[244:245], v26 offset:24576
    ds_read_b64_tr_b16 a[246:247], v26 offset:25600
    ds_read_b64_tr_b16 a[248:249], v25 offset:26624
    ds_read_b64_tr_b16 a[250:251], v25 offset:27648
    ds_read_b64_tr_b16 a[252:253], v26 offset:26624
    ds_read_b64_tr_b16 a[254:255], v26 offset:27648
    v_mfma_f32_32x32x16_bf16 v[80:95], a[232:235], v[44:47], v[80:95]
    buffer_load_dwordx4 v9, s[28:31], s60 offen offset:3072 nt lds
    v_cvt_pk_bf16_f32 v216, v216, v217
    v_add_f32 v106, v106, v218
    v_add_f32 v107, v107, v219
    v_cvt_pk_bf16_f32 v217, v218, v219
    v_add_f32 v106, v106, v220
    v_mfma_f32_32x32x16_bf16 v[128:143], a[236:239], v[40:43], v[128:143]
    v_add_f32 v107, v107, v221
    v_cvt_pk_bf16_f32 v218, v220, v221
    v_add_f32 v106, v106, v222
    v_add_f32 v107, v107, v223
    v_cvt_pk_bf16_f32 v219, v222, v223
    v_mfma_f32_32x32x16_bf16 v[144:159], a[236:239], v[44:47], v[144:159]
    ds_write_b128 v27, v[216:219] offset:3072
    s_waitcnt lgkmcnt(7)
    v_mfma_f32_32x32x16_bf16 v[64:79], a[240:243], v[48:51], v[64:79]
    s_add_u32 m0, s53, 32768
    s_add_u32 s60, s50, 229376
    buffer_load_dwordx4 v6, s[28:31], s60 offen nt lds
    s_waitcnt lgkmcnt(0)
    s_barrier
    ds_read_b128 v[32:35], v28 offset:0
    v_mfma_f32_32x32x16_bf16 v[80:95], a[240:243], v[52:55], v[80:95]
    ds_read_b128 v[36:39], v28 offset:1024
    v_mfma_f32_32x32x16_bf16 v[128:143], a[244:247], v[48:51], v[128:143]
    buffer_load_dwordx4 v7, s[28:31], s60 offen offset:1024 nt lds
    ds_read_b128 v[40:43], v28 offset:2048
    v_mfma_f32_32x32x16_bf16 v[144:159], a[244:247], v[52:55], v[144:159]
    ds_read_b128 v[44:47], v28 offset:3072
    v_mfma_f32_32x32x16_bf16 v[64:79], a[248:251], v[56:59], v[64:79]
    buffer_load_dwordx4 v8, s[28:31], s60 offen offset:2048 nt lds
    s_waitcnt vmcnt(11)
    ds_read_b64_tr_b16 a[64:65], v25 offset:8192
    ds_read_b64_tr_b16 a[66:67], v25 offset:9216
    ds_read_b64_tr_b16 a[68:69], v26 offset:8192
    ds_read_b64_tr_b16 a[70:71], v26 offset:9216
    ds_read_b64_tr_b16 a[72:73], v25 offset:10240
    ds_read_b64_tr_b16 a[74:75], v25 offset:11264
    ds_read_b64_tr_b16 a[76:77], v26 offset:10240
    ds_read_b64_tr_b16 a[78:79], v26 offset:11264
    v_mfma_f32_32x32x16_bf16 v[80:95], a[248:251], v[60:63], v[80:95]
    buffer_load_dwordx4 v9, s[28:31], s60 offen offset:3072 nt lds
    v_mfma_f32_32x32x16_bf16 v[128:143], a[252:255], v[56:59], v[128:143]
    v_mfma_f32_32x32x16_bf16 v[144:159], a[252:255], v[60:63], v[144:159]
    s_waitcnt lgkmcnt(6)
    v_mfma_f32_32x32x16_bf16 v[64:79], a[64:67], v[32:35], v[64:79]
    v_fma_f32 v224, v224, s58, v114
    v_fma_f32 v225, v225, s58, v114
    v_fma_f32 v226, v226, s58, v114
    v_fma_f32 v227, v227, s58, v114
    v_fma_f32 v228, v228, s58, v114
    ds_read_b128 v[48:51], v28 offset:40960
    v_mfma_f32_32x32x16_bf16 v[80:95], a[64:67], v[36:39], v[80:95]
    s_add_u32 m0, s53, 36864
    s_add_u32 s60, s51, 49152
    buffer_load_dwordx4 v6, s[28:31], s60 offen nt lds
    v_fma_f32 v229, v229, s58, v114
    v_fma_f32 v230, v230, s58, v114
    v_fma_f32 v231, v231, s58, v114
    v_exp_f32 v224, v224
    v_exp_f32 v225, v225
    ds_read_b128 v[52:55], v28 offset:41984
    s_waitcnt lgkmcnt(6)
    v_mfma_f32_32x32x16_bf16 v[128:143], a[68:71], v[32:35], v[128:143]
    s_waitcnt lgkmcnt(2)
    v_exp_f32 v226, v226
    v_exp_f32 v227, v227
    v_exp_f32 v228, v228
    v_exp_f32 v229, v229
    v_exp_f32 v230, v230
    ds_read_b128 v[56:59], v28 offset:43008
    v_mfma_f32_32x32x16_bf16 v[144:159], a[68:71], v[36:39], v[144:159]
    buffer_load_dwordx4 v7, s[28:31], s60 offen offset:1024 nt lds
    v_exp_f32 v231, v231
    v_add_f32 v104, v104, v224
    v_add_f32 v105, v105, v225
    v_cvt_pk_bf16_f32 v224, v224, v225
    v_add_f32 v104, v104, v226
    ds_read_b128 v[60:63], v28 offset:44032
    v_mfma_f32_32x32x16_bf16 v[64:79], a[72:75], v[40:43], v[64:79]
    v_add_f32 v105, v105, v227
    v_cvt_pk_bf16_f32 v225, v226, v227
    v_add_f32 v104, v104, v228
    v_add_f32 v105, v105, v229
    v_cvt_pk_bf16_f32 v226, v228, v229
    buffer_load_dwordx4 v8, s[28:31], s60 offen offset:2048 nt lds
    s_waitcnt vmcnt(11)
    ds_read_b64_tr_b16 a[80:81], v25 offset:12288
    ds_read_b64_tr_b16 a[82:83], v25 offset:13312
    ds_read_b64_tr_b16 a[84:85], v26 offset:12288
    ds_read_b64_tr_b16 a[86:87], v26 offset:13312
    ds_read_b64_tr_b16 a[88:89], v25 offset:14336
    ds_read_b64_tr_b16 a[90:91], v25 offset:15360
    ds_read_b64_tr_b16 a[92:93], v26 offset:14336
    ds_read_b64_tr_b16 a[94:95], v26 offset:15360
    v_mfma_f32_32x32x16_bf16 v[80:95], a[72:75], v[44:47], v[80:95]
    buffer_load_dwordx4 v9, s[28:31], s60 offen offset:3072 nt lds
    v_add_f32 v104, v104, v230
    v_add_f32 v105, v105, v231
    v_cvt_pk_bf16_f32 v227, v230, v231
    ds_write_b128 v27, v[224:227] offset:4096
    v_fma_f32 v240, v240, s58, v115
    v_mfma_f32_32x32x16_bf16 v[128:143], a[76:79], v[40:43], v[128:143]
    v_fma_f32 v241, v241, s58, v115
    v_fma_f32 v242, v242, s58, v115
    v_fma_f32 v243, v243, s58, v115
    v_fma_f32 v244, v244, s58, v115
    v_fma_f32 v245, v245, s58, v115
    v_mfma_f32_32x32x16_bf16 v[144:159], a[76:79], v[44:47], v[144:159]
    v_fma_f32 v246, v246, s58, v115
    v_fma_f32 v247, v247, s58, v115
    v_exp_f32 v240, v240
    v_exp_f32 v241, v241
    v_exp_f32 v242, v242
    s_waitcnt lgkmcnt(7)
    v_mfma_f32_32x32x16_bf16 v[64:79], a[80:83], v[48:51], v[64:79]
    s_add_u32 m0, s53, 24576
    s_add_u32 s60, s51, 114688
    buffer_load_dwordx4 v6, s[28:31], s60 offen nt lds
    v_exp_f32 v243, v243
    v_exp_f32 v244, v244
    v_exp_f32 v245, v245
    v_exp_f32 v246, v246
    v_exp_f32 v247, v247
    ds_read_b128 v[32:35], v29 offset:16384
    v_mfma_f32_32x32x16_bf16 v[80:95], a[80:83], v[52:55], v[80:95]
    s_waitcnt lgkmcnt(2)
    v_add_f32 v106, v106, v240
    v_add_f32 v107, v107, v241
    v_cvt_pk_bf16_f32 v240, v240, v241
    v_add_f32 v106, v106, v242
    v_add_f32 v107, v107, v243
    ds_read_b128 v[36:39], v29 offset:17408
    v_mfma_f32_32x32x16_bf16 v[128:143], a[84:87], v[48:51], v[128:143]
    v_cvt_pk_bf16_f32 v241, v242, v243
    v_add_f32 v106, v106, v244
    v_add_f32 v107, v107, v245
    v_cvt_pk_bf16_f32 v242, v244, v245
    v_add_f32 v106, v106, v246
    ds_read_b128 v[40:43], v29 offset:18432
    v_mfma_f32_32x32x16_bf16 v[144:159], a[84:87], v[52:55], v[144:159]
    buffer_load_dwordx4 v7, s[28:31], s60 offen offset:1024 nt lds
    v_add_f32 v107, v107, v247
    v_cvt_pk_bf16_f32 v243, v246, v247
    ds_write_b128 v27, v[240:243] offset:5120
    v_fma_f32 v232, v232, s58, v114
    v_fma_f32 v233, v233, s58, v114
    ds_read_b128 v[44:47], v29 offset:19456
    v_mfma_f32_32x32x16_bf16 v[64:79], a[88:91], v[56:59], v[64:79]
    v_fma_f32 v234, v234, s58, v114
    v_fma_f32 v235, v235, s58, v114
    v_fma_f32 v236, v236, s58, v114
    v_fma_f32 v237, v237, s58, v114
    v_fma_f32 v238, v238, s58, v114
    buffer_load_dwordx4 v8, s[28:31], s60 offen offset:2048 nt lds
    s_waitcnt vmcnt(11)
    ds_read_b64_tr_b16 a[96:97], v25 offset:28672
    ds_read_b64_tr_b16 a[98:99], v25 offset:29696
    ds_read_b64_tr_b16 a[100:101], v26 offset:28672
    ds_read_b64_tr_b16 a[102:103], v26 offset:29696
    ds_read_b64_tr_b16 a[104:105], v25 offset:30720
    ds_read_b64_tr_b16 a[106:107], v25 offset:31744
    ds_read_b64_tr_b16 a[108:109], v26 offset:30720
    ds_read_b64_tr_b16 a[110:111], v26 offset:31744
    v_mfma_f32_32x32x16_bf16 v[80:95], a[88:91], v[60:63], v[80:95]
    buffer_load_dwordx4 v9, s[28:31], s60 offen offset:3072 nt lds
    v_fma_f32 v239, v239, s58, v114
    v_exp_f32 v232, v232
    v_exp_f32 v233, v233
    v_exp_f32 v234, v234
    v_exp_f32 v235, v235
    v_mfma_f32_32x32x16_bf16 v[128:143], a[92:95], v[56:59], v[128:143]
    v_exp_f32 v236, v236
    v_exp_f32 v237, v237
    v_exp_f32 v238, v238
    v_exp_f32 v239, v239
    v_add_f32 v104, v104, v232
    v_mfma_f32_32x32x16_bf16 v[144:159], a[92:95], v[60:63], v[144:159]
    s_add_u32 m0, s53, 8192
    s_add_u32 s60, s51, 180224
    buffer_load_dwordx4 v6, s[28:31], s60 offen nt lds
    v_add_f32 v105, v105, v233
    v_cvt_pk_bf16_f32 v232, v232, v233
    v_add_f32 v104, v104, v234
    v_add_f32 v105, v105, v235
    v_cvt_pk_bf16_f32 v233, v234, v235
    s_waitcnt lgkmcnt(6)
    v_mfma_f32_32x32x16_bf16 v[64:79], a[96:99], v[32:35], v[64:79]
    s_waitcnt lgkmcnt(0)
    v_add_f32 v104, v104, v236
    v_add_f32 v105, v105, v237
    v_cvt_pk_bf16_f32 v234, v236, v237
    v_add_f32 v104, v104, v238
    v_add_f32 v105, v105, v239
    ds_read_b128 v[48:51], v29 offset:57344
    v_mfma_f32_32x32x16_bf16 v[80:95], a[96:99], v[36:39], v[80:95]
    v_cvt_pk_bf16_f32 v235, v238, v239
    ds_write_b128 v27, v[232:235] offset:6144
    v_fma_f32 v248, v248, s58, v115
    v_fma_f32 v249, v249, s58, v115
    v_fma_f32 v250, v250, s58, v115
    ds_read_b128 v[52:55], v29 offset:58368
    v_mfma_f32_32x32x16_bf16 v[128:143], a[100:103], v[32:35], v[128:143]
    v_fma_f32 v251, v251, s58, v115
    v_fma_f32 v252, v252, s58, v115
    v_fma_f32 v253, v253, s58, v115
    v_fma_f32 v254, v254, s58, v115
    v_fma_f32 v255, v255, s58, v115
    ds_read_b128 v[56:59], v29 offset:59392
    v_mfma_f32_32x32x16_bf16 v[144:159], a[100:103], v[36:39], v[144:159]
    buffer_load_dwordx4 v7, s[28:31], s60 offen offset:1024 nt lds
    v_exp_f32 v248, v248
    v_exp_f32 v249, v249
    v_exp_f32 v250, v250
    v_exp_f32 v251, v251
    v_exp_f32 v252, v252
    ds_read_b128 v[60:63], v29 offset:60416
    v_mfma_f32_32x32x16_bf16 v[64:79], a[104:107], v[40:43], v[64:79]
    v_exp_f32 v253, v253
    v_exp_f32 v254, v254
    v_exp_f32 v255, v255
    v_add_f32 v106, v106, v248
    v_add_f32 v107, v107, v249
    buffer_load_dwordx4 v8, s[28:31], s60 offen offset:2048 nt lds
    s_waitcnt vmcnt(11)
    ds_read_b64_tr_b16 a[112:113], v25 offset:32768
    ds_read_b64_tr_b16 a[114:115], v25 offset:33792
    ds_read_b64_tr_b16 a[116:117], v26 offset:32768
    ds_read_b64_tr_b16 a[118:119], v26 offset:33792
    ds_read_b64_tr_b16 a[120:121], v25 offset:34816
    ds_read_b64_tr_b16 a[122:123], v25 offset:35840
    ds_read_b64_tr_b16 a[124:125], v26 offset:34816
    ds_read_b64_tr_b16 a[126:127], v26 offset:35840
    v_mfma_f32_32x32x16_bf16 v[80:95], a[104:107], v[44:47], v[80:95]
    buffer_load_dwordx4 v9, s[28:31], s60 offen offset:3072 nt lds
    v_cvt_pk_bf16_f32 v248, v248, v249
    v_add_f32 v106, v106, v250
    v_add_f32 v107, v107, v251
    v_cvt_pk_bf16_f32 v249, v250, v251
    v_add_f32 v106, v106, v252
    v_mfma_f32_32x32x16_bf16 v[128:143], a[108:111], v[40:43], v[128:143]
    v_add_f32 v107, v107, v253
    v_cvt_pk_bf16_f32 v250, v252, v253
    v_add_f32 v106, v106, v254
    v_add_f32 v107, v107, v255
    v_cvt_pk_bf16_f32 v251, v254, v255
    v_mfma_f32_32x32x16_bf16 v[144:159], a[108:111], v[44:47], v[144:159]
    ds_write_b128 v27, v[248:251] offset:7168
    s_waitcnt lgkmcnt(7)
    v_mfma_f32_32x32x16_bf16 v[64:79], a[112:115], v[48:51], v[64:79]
    s_add_u32 m0, s53, 12288
    s_add_u32 s60, s51, 245760
    buffer_load_dwordx4 v6, s[28:31], s60 offen nt lds
    s_waitcnt lgkmcnt(0)
    s_barrier
    ds_read_b128 v[32:35], v28 offset:4096
    v_mfma_f32_32x32x16_bf16 v[80:95], a[112:115], v[52:55], v[80:95]
    ds_read_b128 v[36:39], v28 offset:5120
    v_mfma_f32_32x32x16_bf16 v[128:143], a[116:119], v[48:51], v[128:143]
    buffer_load_dwordx4 v7, s[28:31], s60 offen offset:1024 nt lds
    ds_read_b128 v[40:43], v28 offset:6144
    v_mfma_f32_32x32x16_bf16 v[144:159], a[116:119], v[52:55], v[144:159]
    ds_read_b128 v[44:47], v28 offset:7168
    v_mfma_f32_32x32x16_bf16 v[64:79], a[120:123], v[56:59], v[64:79]
    buffer_load_dwordx4 v8, s[28:31], s60 offen offset:2048 nt lds
    s_waitcnt vmcnt(11)
    ds_read_b64_tr_b16 a[128:129], v25 offset:36864
    ds_read_b64_tr_b16 a[130:131], v25 offset:37888
    ds_read_b64_tr_b16 a[132:133], v26 offset:36864
    ds_read_b64_tr_b16 a[134:135], v26 offset:37888
    ds_read_b64_tr_b16 a[136:137], v25 offset:38912
    ds_read_b64_tr_b16 a[138:139], v25 offset:39936
    ds_read_b64_tr_b16 a[140:141], v26 offset:38912
    ds_read_b64_tr_b16 a[142:143], v26 offset:39936
    v_mfma_f32_32x32x16_bf16 v[80:95], a[120:123], v[60:63], v[80:95]
    buffer_load_dwordx4 v9, s[28:31], s60 offen offset:3072 nt lds
    v_mfma_f32_32x32x16_bf16 v[128:143], a[124:127], v[56:59], v[128:143]
    v_mfma_f32_32x32x16_bf16 v[144:159], a[124:127], v[60:63], v[144:159]
    s_waitcnt lgkmcnt(6)
    v_mfma_f32_32x32x16_bf16 v[64:79], a[128:131], v[32:35], v[64:79]
    v_add_f32 v104, v104, v105
    v_add_f32 v106, v106, v107
    s_nop 1
    v_permlane32_swap_b32 v104, v106
    v_add_f32 v104, v104, v106
    ds_read_b128 v[48:51], v28 offset:45056
    v_mfma_f32_32x32x16_bf16 v[80:95], a[128:131], v[36:39], v[80:95]
    ds_read_b128 v[52:55], v28 offset:46080
    s_waitcnt lgkmcnt(6)
    v_mfma_f32_32x32x16_bf16 v[128:143], a[132:135], v[32:35], v[128:143]
    s_waitcnt lgkmcnt(2)
    ds_read_b128 v[56:59], v28 offset:47104
    v_mfma_f32_32x32x16_bf16 v[144:159], a[132:135], v[36:39], v[144:159]
    ds_read_b128 v[60:63], v28 offset:48128
    v_mfma_f32_32x32x16_bf16 v[64:79], a[136:139], v[40:43], v[64:79]
    s_waitcnt vmcnt(8)
    ds_read_b64_tr_b16 a[144:145], v25 offset:24576
    ds_read_b64_tr_b16 a[146:147], v25 offset:25600
    ds_read_b64_tr_b16 a[148:149], v26 offset:24576
    ds_read_b64_tr_b16 a[150:151], v26 offset:25600
    ds_read_b64_tr_b16 a[152:153], v25 offset:26624
    ds_read_b64_tr_b16 a[154:155], v25 offset:27648
    ds_read_b64_tr_b16 a[156:157], v26 offset:26624
    ds_read_b64_tr_b16 a[158:159], v26 offset:27648
    v_mfma_f32_32x32x16_bf16 v[80:95], a[136:139], v[44:47], v[80:95]
    v_mfma_f32_32x32x16_bf16 v[128:143], a[140:143], v[40:43], v[128:143]
    v_mfma_f32_32x32x16_bf16 v[144:159], a[140:143], v[44:47], v[144:159]
    s_waitcnt lgkmcnt(6)
    v_mfma_f32_32x32x16_bf16 v[64:79], a[144:147], v[48:51], v[64:79]
    ds_read_b128 v[32:35], v29 offset:20480
    v_mfma_f32_32x32x16_bf16 v[80:95], a[144:147], v[52:55], v[80:95]
    ds_read_b128 v[36:39], v29 offset:21504
    s_waitcnt lgkmcnt(6)
    v_mfma_f32_32x32x16_bf16 v[128:143], a[148:151], v[48:51], v[128:143]
    s_waitcnt lgkmcnt(2)
    s_add_u32 m0, s53, 28672
    s_add_u32 s60, s92, 0
    buffer_load_dwordx4 v14, s[36:39], s60 offen lds
    ds_read_b128 v[40:43], v29 offset:22528
    v_mfma_f32_32x32x16_bf16 v[144:159], a[148:151], v[52:55], v[144:159]
    buffer_load_dwordx4 v15, s[36:39], s60 offen offset:1024 lds
    ds_read_b128 v[44:47], v29 offset:23552
    v_mfma_f32_32x32x16_bf16 v[64:79], a[152:155], v[56:59], v[64:79]
    buffer_load_dwordx4 v16, s[36:39], s60 offen offset:2048 lds
    buffer_load_dwordx4 v17, s[36:39], s60 offen offset:3072 lds
    s_waitcnt vmcnt(8)
    ds_read_b64_tr_b16 a[160:161], v25 offset:8192
    ds_read_b64_tr_b16 a[162:163], v25 offset:9216
    ds_read_b64_tr_b16 a[164:165], v26 offset:8192
    ds_read_b64_tr_b16 a[166:167], v26 offset:9216
    ds_read_b64_tr_b16 a[168:169], v25 offset:10240
    ds_read_b64_tr_b16 a[170:171], v25 offset:11264
    ds_read_b64_tr_b16 a[172:173], v26 offset:10240
    ds_read_b64_tr_b16 a[174:175], v26 offset:11264
    v_mfma_f32_32x32x16_bf16 v[80:95], a[152:155], v[60:63], v[80:95]
    v_mfma_f32_32x32x16_bf16 v[128:143], a[156:159], v[56:59], v[128:143]
    v_mfma_f32_32x32x16_bf16 v[144:159], a[156:159], v[60:63], v[144:159]
    s_waitcnt lgkmcnt(6)
    v_mfma_f32_32x32x16_bf16 v[64:79], a[160:163], v[32:35], v[64:79]
    ds_read_b128 v[48:51], v29 offset:61440
    v_mfma_f32_32x32x16_bf16 v[80:95], a[160:163], v[36:39], v[80:95]
    ds_read_b128 v[52:55], v29 offset:62464
    s_waitcnt lgkmcnt(6)
    v_mfma_f32_32x32x16_bf16 v[128:143], a[164:167], v[32:35], v[128:143]
    s_waitcnt lgkmcnt(2)
    s_add_u32 m0, s53, 32768
    s_add_u32 s60, s92, 28672
    buffer_load_dwordx4 v14, s[36:39], s60 offen lds
    ds_read_b128 v[56:59], v29 offset:63488
    v_mfma_f32_32x32x16_bf16 v[144:159], a[164:167], v[36:39], v[144:159]
    buffer_load_dwordx4 v15, s[36:39], s60 offen offset:1024 lds
    ds_read_b128 v[60:63], v29 offset:64512
    v_mfma_f32_32x32x16_bf16 v[64:79], a[168:171], v[40:43], v[64:79]
    buffer_load_dwordx4 v16, s[36:39], s60 offen offset:2048 lds
    buffer_load_dwordx4 v17, s[36:39], s60 offen offset:3072 lds
    s_waitcnt vmcnt(8)
    ds_read_b64_tr_b16 a[176:177], v25 offset:12288
    ds_read_b64_tr_b16 a[178:179], v25 offset:13312
    ds_read_b64_tr_b16 a[180:181], v26 offset:12288
    ds_read_b64_tr_b16 a[182:183], v26 offset:13312
    ds_read_b64_tr_b16 a[184:185], v25 offset:14336
    ds_read_b64_tr_b16 a[186:187], v25 offset:15360
    ds_read_b64_tr_b16 a[188:189], v26 offset:14336
    ds_read_b64_tr_b16 a[190:191], v26 offset:15360
    v_mfma_f32_32x32x16_bf16 v[80:95], a[168:171], v[44:47], v[80:95]
    v_mfma_f32_32x32x16_bf16 v[128:143], a[172:175], v[40:43], v[128:143]
    v_mfma_f32_32x32x16_bf16 v[144:159], a[172:175], v[44:47], v[144:159]
    s_waitcnt lgkmcnt(6)
    v_mfma_f32_32x32x16_bf16 v[64:79], a[176:179], v[48:51], v[64:79]
    v_mfma_f32_32x32x16_bf16 v[80:95], a[176:179], v[52:55], v[80:95]
    s_waitcnt vmcnt(4)
    ds_read_b64_tr_b16 a[0:1], v23 offset:28672
    ds_read_b64_tr_b16 a[2:3], v23 offset:29184
    ds_write_b32 v31, v104 offset:8192
    s_waitcnt lgkmcnt(7)
    v_mfma_f32_32x32x16_bf16 v[128:143], a[180:183], v[48:51], v[128:143]
    s_waitcnt lgkmcnt(3)
    s_add_u32 m0, s53, 12288
    s_add_u32 s60, s93, 0
    buffer_load_dwordx4 v14, s[36:39], s60 offen lds
    ds_read_b64_tr_b16 a[4:5], v24 offset:28672
    ds_read_b64_tr_b16 a[6:7], v24 offset:29184
    v_mfma_f32_32x32x16_bf16 v[144:159], a[180:183], v[52:55], v[144:159]
    buffer_load_dwordx4 v15, s[36:39], s60 offen offset:1024 lds
    ds_read_b64_tr_b16 a[8:9], v23 offset:30720
    ds_read_b64_tr_b16 a[10:11], v23 offset:31232
    v_mfma_f32_32x32x16_bf16 v[64:79], a[184:187], v[56:59], v[64:79]
    buffer_load_dwordx4 v16, s[36:39], s60 offen offset:2048 lds
    ds_read_b64_tr_b16 a[12:13], v24 offset:30720
    ds_read_b64_tr_b16 a[14:15], v24 offset:31232
    v_mfma_f32_32x32x16_bf16 v[80:95], a[184:187], v[60:63], v[80:95]
    buffer_load_dwordx4 v17, s[36:39], s60 offen offset:3072 lds
    v_mfma_f32_32x32x16_bf16 v[128:143], a[188:191], v[56:59], v[128:143]
    s_waitcnt vmcnt(4)
    ds_read_b64_tr_b16 a[16:17], v23 offset:32768
    ds_read_b64_tr_b16 a[18:19], v23 offset:33280
    v_mfma_f32_32x32x16_bf16 v[144:159], a[188:191], v[60:63], v[144:159]
    ds_read_b64_tr_b16 a[20:21], v24 offset:32768
    ds_read_b64_tr_b16 a[22:23], v24 offset:33280
    v_cvt_pk_bf16_f32 v32, v64, v65
    ds_read_b64_tr_b16 a[24:25], v23 offset:34816
    v_cvt_pk_bf16_f32 v33, v66, v67
    ds_read_b64_tr_b16 a[26:27], v23 offset:35328
    v_cvt_pk_bf16_f32 v34, v68, v69
    ds_read_b64_tr_b16 a[28:29], v24 offset:34816
    v_cvt_pk_bf16_f32 v35, v70, v71
    ds_read_b64_tr_b16 a[30:31], v24 offset:35328
    ds_write_b128 v27, v[32:35] offset:36864
    v_cvt_pk_bf16_f32 v36, v80, v81
    v_cvt_pk_bf16_f32 v37, v82, v83
    v_cvt_pk_bf16_f32 v38, v84, v85
    v_cvt_pk_bf16_f32 v39, v86, v87
    ds_write_b128 v27, v[36:39] offset:37888
    s_waitcnt lgkmcnt(10)
    s_add_u32 m0, s53, 28672
    s_add_u32 s60, s93, 28672
    buffer_load_dwordx4 v14, s[36:39], s60 offen lds
    v_cvt_pk_bf16_f32 v40, v72, v73
    buffer_load_dwordx4 v15, s[36:39], s60 offen offset:1024 lds
    v_cvt_pk_bf16_f32 v41, v74, v75
    buffer_load_dwordx4 v16, s[36:39], s60 offen offset:2048 lds
    v_cvt_pk_bf16_f32 v42, v76, v77
    buffer_load_dwordx4 v17, s[36:39], s60 offen offset:3072 lds
    v_cvt_pk_bf16_f32 v43, v78, v79
    ds_write_b128 v27, v[40:43] offset:38912
    v_cvt_pk_bf16_f32 v44, v88, v89
    v_cvt_pk_bf16_f32 v45, v90, v91
    v_cvt_pk_bf16_f32 v46, v92, v93
    v_cvt_pk_bf16_f32 v47, v94, v95
    ds_write_b128 v27, v[44:47] offset:39936
    s_waitcnt lgkmcnt(4)
    s_add_u32 m0, s53, 32768
    s_add_u32 s60, s94, 0
    buffer_load_dwordx4 v14, s[36:39], s60 offen lds
    v_cvt_pk_bf16_f32 v48, v128, v129
    buffer_load_dwordx4 v15, s[36:39], s60 offen offset:1024 lds
    v_cvt_pk_bf16_f32 v49, v130, v131
    buffer_load_dwordx4 v16, s[36:39], s60 offen offset:2048 lds
    v_cvt_pk_bf16_f32 v50, v132, v133
    buffer_load_dwordx4 v17, s[36:39], s60 offen offset:3072 lds
    v_cvt_pk_bf16_f32 v51, v134, v135
    ds_write_b128 v27, v[48:51] offset:24576
    v_cvt_pk_bf16_f32 v52, v144, v145
    v_cvt_pk_bf16_f32 v53, v146, v147
    v_cvt_pk_bf16_f32 v54, v148, v149
    v_cvt_pk_bf16_f32 v55, v150, v151
    ds_write_b128 v27, v[52:55] offset:25600
    v_cvt_pk_bf16_f32 v56, v136, v137
    v_cvt_pk_bf16_f32 v57, v138, v139
    v_cvt_pk_bf16_f32 v58, v140, v141
    v_cvt_pk_bf16_f32 v59, v142, v143
    ds_write_b128 v27, v[56:59] offset:26624
    v_cvt_pk_bf16_f32 v60, v152, v153
    v_cvt_pk_bf16_f32 v61, v154, v155
    v_cvt_pk_bf16_f32 v62, v156, v157
    v_cvt_pk_bf16_f32 v63, v158, v159
    ds_write_b128 v27, v[60:63] offset:27648
    v_mfma_f32_32x32x16_bf16 v[192:207], a[0:3], v[32:35], 0
    v_mfma_f32_32x32x16_bf16 v[208:223], a[0:3], v[36:39], 0
    s_waitcnt vmcnt(8)
    ds_read_b64_tr_b16 a[64:65], v23 offset:12288
    ds_read_b64_tr_b16 a[66:67], v23 offset:12800
    v_mfma_f32_32x32x16_bf16 v[192:207], a[8:11], v[40:43], v[192:207]
    ds_read_b64_tr_b16 a[68:69], v24 offset:12288
    ds_read_b64_tr_b16 a[70:71], v24 offset:12800
    v_mfma_f32_32x32x16_bf16 v[208:223], a[8:11], v[44:47], v[208:223]
    ds_read_b64_tr_b16 a[72:73], v23 offset:14336
    ds_read_b64_tr_b16 a[74:75], v23 offset:14848
    v_mfma_f32_32x32x16_bf16 v[224:239], a[4:7], v[32:35], 0
    ds_read_b64_tr_b16 a[76:77], v24 offset:14336
    ds_read_b64_tr_b16 a[78:79], v24 offset:14848
    v_mfma_f32_32x32x16_bf16 v[240:255], a[4:7], v[36:39], 0
    s_waitcnt lgkmcnt(0)
    s_barrier
    ds_read_b128 a[32:35], v121 offset:36864
    ds_read_b128 a[36:39], v121 offset:37888
    v_mfma_f32_32x32x16_bf16 v[224:239], a[12:15], v[40:43], v[224:239]
    s_add_u32 m0, s53, 16384
    s_add_u32 s60, s94, 28672
    buffer_load_dwordx4 v14, s[36:39], s60 offen lds
    ds_read_b128 a[40:43], v121 offset:38912
    ds_read_b128 a[44:47], v121 offset:39936
    v_mfma_f32_32x32x16_bf16 v[240:255], a[12:15], v[44:47], v[240:255]
    buffer_load_dwordx4 v15, s[36:39], s60 offen offset:1024 lds
    s_waitcnt vmcnt(6)
    ds_read_b64_tr_b16 a[80:81], v23 offset:28672
    ds_read_b64_tr_b16 a[82:83], v23 offset:29184
    ds_read_b128 a[48:51], v121 offset:24576
    ds_read_b128 a[52:55], v121 offset:25600
    v_mfma_f32_32x32x16_bf16 v[192:207], a[16:19], v[48:51], v[192:207]
    buffer_load_dwordx4 v16, s[36:39], s60 offen offset:2048 lds
    ds_read_b64_tr_b16 a[84:85], v24 offset:28672
    ds_read_b64_tr_b16 a[86:87], v24 offset:29184
    ds_read_b128 a[56:59], v121 offset:26624
    ds_read_b128 a[60:63], v121 offset:27648
    v_mfma_f32_32x32x16_bf16 v[208:223], a[16:19], v[52:55], v[208:223]
    buffer_load_dwordx4 v17, s[36:39], s60 offen offset:3072 lds
    ds_read_b64_tr_b16 a[88:89], v23 offset:30720
    ds_read_b64_tr_b16 a[90:91], v23 offset:31232
    ds_read_b128 a[192:195], v122 offset:36864
    ds_read_b128 a[196:199], v122 offset:37888
    v_mfma_f32_32x32x16_bf16 v[192:207], a[24:27], v[56:59], v[192:207]
    s_add_u32 m0, s53, 20480
    s_add_u32 s60, s95, 0
    buffer_load_dwordx4 v14, s[36:39], s60 offen lds
    ds_read_b64_tr_b16 a[92:93], v24 offset:30720
    ds_read_b64_tr_b16 a[94:95], v24 offset:31232
    ds_read_b128 a[200:203], v122 offset:38912
    ds_read_b128 a[204:207], v122 offset:39936
    v_mfma_f32_32x32x16_bf16 v[208:223], a[24:27], v[60:63], v[208:223]
    buffer_load_dwordx4 v15, s[36:39], s60 offen offset:1024 lds
    s_waitcnt vmcnt(6)
    ds_read_b64_tr_b16 a[96:97], v23 offset:32768
    ds_read_b64_tr_b16 a[98:99], v23 offset:33280
    ds_read_b128 a[208:211], v122 offset:24576
    ds_read_b128 a[212:215], v122 offset:25600
    v_mfma_f32_32x32x16_bf16 v[224:239], a[20:23], v[48:51], v[224:239]
    buffer_load_dwordx4 v16, s[36:39], s60 offen offset:2048 lds
    ds_read_b64_tr_b16 a[100:101], v24 offset:32768
    ds_read_b64_tr_b16 a[102:103], v24 offset:33280
    ds_read_b128 a[216:219], v122 offset:26624
    ds_read_b128 a[220:223], v122 offset:27648
    v_mfma_f32_32x32x16_bf16 v[240:255], a[20:23], v[52:55], v[240:255]
    buffer_load_dwordx4 v17, s[36:39], s60 offen offset:3072 lds
    ds_read_b64_tr_b16 a[104:105], v23 offset:34816
    ds_read_b64_tr_b16 a[106:107], v23 offset:35328
    ds_read_b128 a[224:227], v123 offset:36864
    ds_read_b128 a[228:231], v123 offset:37888
    v_mfma_f32_32x32x16_bf16 v[224:239], a[28:31], v[56:59], v[224:239]
    s_add_u32 m0, s53, 0
    s_add_u32 s60, s95, 28672
    buffer_load_dwordx4 v14, s[36:39], s60 offen lds
    ds_read_b64_tr_b16 a[108:109], v24 offset:34816
    ds_read_b64_tr_b16 a[110:111], v24 offset:35328
    ds_read_b128 a[232:235], v123 offset:38912
    ds_read_b128 a[236:239], v123 offset:39936
    v_mfma_f32_32x32x16_bf16 v[240:255], a[28:31], v[60:63], v[240:255]
    s_waitcnt lgkmcnt(14)
    buffer_load_dwordx4 v15, s[36:39], s60 offen offset:1024 lds
    ds_read_b128 a[240:243], v123 offset:24576
    ds_read_b128 a[244:247], v123 offset:25600
    v_mfma_f32_32x32x16_bf16 v[192:207], a[64:67], a[32:35], v[192:207]
    buffer_load_dwordx4 v16, s[36:39], s60 offen offset:2048 lds
    ds_read_b128 a[248:251], v123 offset:26624
    ds_read_b128 a[252:255], v123 offset:27648
    v_mfma_f32_32x32x16_bf16 v[208:223], a[64:67], a[36:39], v[208:223]
    buffer_load_dwordx4 v17, s[36:39], s60 offen offset:3072 lds
    ds_read_b32 v96, v108 offset:8192
    ds_read_b32 v97, v108 offset:8320
    v_mfma_f32_32x32x16_bf16 v[192:207], a[72:75], a[40:43], v[192:207]
    ds_read_b32 v98, v109 offset:8192
    ds_read_b32 v99, v109 offset:8320
    v_mfma_f32_32x32x16_bf16 v[208:223], a[72:75], a[44:47], v[208:223]
    ds_read_b32 v100, v110 offset:8192
    ds_read_b32 v101, v110 offset:8320
    v_mfma_f32_32x32x16_bf16 v[224:239], a[68:71], a[32:35], v[224:239]
    s_waitcnt lgkmcnt(12)
    s_add_u32 m0, s53, 4096
    s_add_u32 s60, s96, 0
    buffer_load_dwordx4 v14, s[36:39], s60 offen lds
    ds_read_b32 v102, v111 offset:8192
    ds_read_b32 v103, v111 offset:8320
    v_mfma_f32_32x32x16_bf16 v[240:255], a[68:71], a[36:39], v[240:255]
    buffer_load_dwordx4 v15, s[36:39], s60 offen offset:1024 lds
    s_waitcnt lgkmcnt(5)
    v_add_f32 v114, v96, v98
    s_waitcnt lgkmcnt(1)
    v_add_f32 v100, v100, v102
    v_mfma_f32_32x32x16_bf16 v[224:239], a[76:79], a[40:43], v[224:239]
    buffer_load_dwordx4 v16, s[36:39], s60 offen offset:2048 lds
    v_add_f32 v114, v114, v100
    v_rcp_f32 v114, v114
    v_mfma_f32_32x32x16_bf16 v[240:255], a[76:79], a[44:47], v[240:255]
    buffer_load_dwordx4 v17, s[36:39], s60 offen offset:3072 lds
    s_waitcnt vmcnt(12)
    ds_read_b64_tr_b16 a[112:113], v23 offset:16384
    ds_read_b64_tr_b16 a[114:115], v23 offset:16896
    v_add_f32 v115, v97, v99
    s_waitcnt lgkmcnt(2)
    v_add_f32 v101, v101, v103
    v_mfma_f32_32x32x16_bf16 v[192:207], a[80:83], a[48:51], v[192:207]
    s_add_u32 m0, s53, 12288
    s_add_u32 s60, s96, 28672
    buffer_load_dwordx4 v14, s[36:39], s60 offen lds
    ds_read_b64_tr_b16 a[116:117], v24 offset:16384
    ds_read_b64_tr_b16 a[118:119], v24 offset:16896
    v_add_f32 v115, v115, v101
    v_rcp_f32 v115, v115
    v_mfma_f32_32x32x16_bf16 v[208:223], a[80:83], a[52:55], v[208:223]
    buffer_load_dwordx4 v15, s[36:39], s60 offen offset:1024 lds
    ds_read_b64_tr_b16 a[120:121], v23 offset:18432
    ds_read_b64_tr_b16 a[122:123], v23 offset:18944
    v_mfma_f32_32x32x16_bf16 v[192:207], a[88:91], a[56:59], v[192:207]
    buffer_load_dwordx4 v16, s[36:39], s60 offen offset:2048 lds
    ds_read_b64_tr_b16 a[124:125], v24 offset:18432
    ds_read_b64_tr_b16 a[126:127], v24 offset:18944
    v_mfma_f32_32x32x16_bf16 v[208:223], a[88:91], a[60:63], v[208:223]
    buffer_load_dwordx4 v17, s[36:39], s60 offen offset:3072 lds
    s_waitcnt vmcnt(12)
    ds_read_b64_tr_b16 a[128:129], v23 offset:20480
    ds_read_b64_tr_b16 a[130:131], v23 offset:20992
    v_mfma_f32_32x32x16_bf16 v[224:239], a[84:87], a[48:51], v[224:239]
    ds_read_b64_tr_b16 a[132:133], v24 offset:20480
    ds_read_b64_tr_b16 a[134:135], v24 offset:20992
    v_mfma_f32_32x32x16_bf16 v[240:255], a[84:87], a[52:55], v[240:255]
    s_add_u32 m0, s53, 28672
    s_add_u32 s60, s97, 0
    buffer_load_dwordx4 v14, s[36:39], s60 offen lds
    ds_read_b64_tr_b16 a[136:137], v23 offset:22528
    ds_read_b64_tr_b16 a[138:139], v23 offset:23040
    v_mfma_f32_32x32x16_bf16 v[224:239], a[92:95], a[56:59], v[224:239]
    buffer_load_dwordx4 v15, s[36:39], s60 offen offset:1024 lds
    ds_read_b64_tr_b16 a[140:141], v24 offset:22528
    ds_read_b64_tr_b16 a[142:143], v24 offset:23040
    v_mfma_f32_32x32x16_bf16 v[240:255], a[92:95], a[60:63], v[240:255]
    buffer_load_dwordx4 v16, s[36:39], s60 offen offset:2048 lds
    v_mfma_f32_32x32x16_bf16 v[192:207], a[96:99], a[192:195], v[192:207]
    s_waitcnt lgkmcnt(8)
    buffer_load_dwordx4 v17, s[36:39], s60 offen offset:3072 lds
    s_waitcnt vmcnt(12)
    ds_read_b64_tr_b16 a[144:145], v23 offset:0
    ds_read_b64_tr_b16 a[146:147], v23 offset:512
    v_mfma_f32_32x32x16_bf16 v[208:223], a[96:99], a[196:199], v[208:223]
    ds_read_b64_tr_b16 a[148:149], v24 offset:0
    ds_read_b64_tr_b16 a[150:151], v24 offset:512
    v_mfma_f32_32x32x16_bf16 v[192:207], a[104:107], a[200:203], v[192:207]
    s_add_u32 m0, s53, 32768
    s_add_u32 s60, s97, 28672
    buffer_load_dwordx4 v14, s[36:39], s60 offen lds
    ds_read_b64_tr_b16 a[152:153], v23 offset:2048
    ds_read_b64_tr_b16 a[154:155], v23 offset:2560
    v_mfma_f32_32x32x16_bf16 v[208:223], a[104:107], a[204:207], v[208:223]
    buffer_load_dwordx4 v15, s[36:39], s60 offen offset:1024 lds
    ds_read_b64_tr_b16 a[156:157], v24 offset:2048
    ds_read_b64_tr_b16 a[158:159], v24 offset:2560
    v_mfma_f32_32x32x16_bf16 v[224:239], a[100:103], a[192:195], v[224:239]
    s_waitcnt lgkmcnt(8)
    v_mfma_f32_32x32x16_bf16 v[240:255], a[100:103], a[196:199], v[240:255]
    buffer_load_dwordx4 v16, s[36:39], s60 offen offset:2048 lds
    s_waitcnt vmcnt(11)
    ds_read_b64_tr_b16 a[160:161], v23 offset:4096
    ds_read_b64_tr_b16 a[162:163], v23 offset:4608
    v_mfma_f32_32x32x16_bf16 v[224:239], a[108:111], a[200:203], v[224:239]
    buffer_load_dwordx4 v17, s[36:39], s60 offen offset:3072 lds
    ds_read_b64_tr_b16 a[164:165], v24 offset:4096
    ds_read_b64_tr_b16 a[166:167], v24 offset:4608
    v_mfma_f32_32x32x16_bf16 v[240:255], a[108:111], a[204:207], v[240:255]
    s_add_u32 m0, s53, 16384
    s_add_u32 s60, s98, 0
    buffer_load_dwordx4 v14, s[36:39], s60 offen lds
    ds_read_b64_tr_b16 a[168:169], v23 offset:6144
    ds_read_b64_tr_b16 a[170:171], v23 offset:6656
    v_mfma_f32_32x32x16_bf16 v[192:207], a[112:115], a[208:211], v[192:207]
    buffer_load_dwordx4 v15, s[36:39], s60 offen offset:1024 lds
    ds_read_b64_tr_b16 a[172:173], v24 offset:6144
    ds_read_b64_tr_b16 a[174:175], v24 offset:6656
    v_mfma_f32_32x32x16_bf16 v[208:223], a[112:115], a[212:215], v[208:223]
    s_waitcnt lgkmcnt(8)
    buffer_load_dwordx4 v16, s[36:39], s60 offen offset:2048 lds
    v_mfma_f32_32x32x16_bf16 v[192:207], a[120:123], a[216:219], v[192:207]
    v_mfma_f32_32x32x16_bf16 v[208:223], a[120:123], a[220:223], v[208:223]
    buffer_load_dwordx4 v17, s[36:39], s60 offen offset:3072 lds
    s_waitcnt vmcnt(12)
    ds_read_b64_tr_b16 a[176:177], v23 offset:12288
    ds_read_b64_tr_b16 a[178:179], v23 offset:12800
    v_mfma_f32_32x32x16_bf16 v[224:239], a[116:119], a[208:211], v[224:239]
    s_add_u32 m0, s53, 20480
    s_add_u32 s60, s98, 28672
    buffer_load_dwordx4 v14, s[36:39], s60 offen lds
    ds_read_b64_tr_b16 a[180:181], v24 offset:12288
    ds_read_b64_tr_b16 a[182:183], v24 offset:12800
    v_mfma_f32_32x32x16_bf16 v[240:255], a[116:119], a[212:215], v[240:255]
    buffer_load_dwordx4 v15, s[36:39], s60 offen offset:1024 lds
    ds_read_b64_tr_b16 a[184:185], v23 offset:14336
    ds_read_b64_tr_b16 a[186:187], v23 offset:14848
    v_mfma_f32_32x32x16_bf16 v[224:239], a[124:127], a[216:219], v[224:239]
    s_waitcnt lgkmcnt(6)
    buffer_load_dwordx4 v16, s[36:39], s60 offen offset:2048 lds
    ds_read_b64_tr_b16 a[188:189], v24 offset:14336
    ds_read_b64_tr_b16 a[190:191], v24 offset:14848
    v_mfma_f32_32x32x16_bf16 v[240:255], a[124:127], a[220:223], v[240:255]
    v_mfma_f32_32x32x16_bf16 v[192:207], a[128:131], a[224:227], v[192:207]
    buffer_load_dwordx4 v17, s[36:39], s60 offen offset:3072 lds
    s_waitcnt vmcnt(12)
    ds_read_b64_tr_b16 a[0:1], v23 offset:28672
    ds_read_b64_tr_b16 a[2:3], v23 offset:29184
    v_mfma_f32_32x32x16_bf16 v[208:223], a[128:131], a[228:231], v[208:223]
    s_add_u32 m0, s53, 0
    s_add_u32 s60, s99, 0
    buffer_load_dwordx4 v14, s[36:39], s60 offen lds
    ds_read_b64_tr_b16 a[4:5], v24 offset:28672
    ds_read_b64_tr_b16 a[6:7], v24 offset:29184
    v_mfma_f32_32x32x16_bf16 v[192:207], a[136:139], a[232:235], v[192:207]
    buffer_load_dwordx4 v15, s[36:39], s60 offen offset:1024 lds
    ds_read_b64_tr_b16 a[8:9], v23 offset:30720
    ds_read_b64_tr_b16 a[10:11], v23 offset:31232
    v_mfma_f32_32x32x16_bf16 v[208:223], a[136:139], a[236:239], v[208:223]
    ds_read_b64_tr_b16 a[12:13], v24 offset:30720
    ds_read_b64_tr_b16 a[14:15], v24 offset:31232
    v_mfma_f32_32x32x16_bf16 v[224:239], a[132:135], a[224:227], v[224:239]
    s_waitcnt lgkmcnt(8)
    buffer_load_dwordx4 v16, s[36:39], s60 offen offset:2048 lds
    s_waitcnt vmcnt(11)
    ds_read_b64_tr_b16 a[16:17], v23 offset:32768
    ds_read_b64_tr_b16 a[18:19], v23 offset:33280
    v_mfma_f32_32x32x16_bf16 v[240:255], a[132:135], a[228:231], v[240:255]
    buffer_load_dwordx4 v17, s[36:39], s60 offen offset:3072 lds
    ds_read_b64_tr_b16 a[20:21], v24 offset:32768
    ds_read_b64_tr_b16 a[22:23], v24 offset:33280
    v_mfma_f32_32x32x16_bf16 v[224:239], a[140:143], a[232:235], v[224:239]
    s_add_u32 m0, s53, 4096
    s_add_u32 s60, s99, 28672
    buffer_load_dwordx4 v14, s[36:39], s60 offen lds
    ds_read_b64_tr_b16 a[24:25], v23 offset:34816
    ds_read_b64_tr_b16 a[26:27], v23 offset:35328
    v_mfma_f32_32x32x16_bf16 v[240:255], a[140:143], a[236:239], v[240:255]
    buffer_load_dwordx4 v15, s[36:39], s60 offen offset:1024 lds
    ds_read_b64_tr_b16 a[28:29], v24 offset:34816
    ds_read_b64_tr_b16 a[30:31], v24 offset:35328
    v_mfma_f32_32x32x16_bf16 v[192:207], a[144:147], a[240:243], v[192:207]
    buffer_load_dwordx4 v16, s[36:39], s60 offen offset:2048 lds
    v_mfma_f32_32x32x16_bf16 v[208:223], a[144:147], a[244:247], v[208:223]
    s_waitcnt lgkmcnt(8)
    v_mfma_f32_32x32x16_bf16 v[192:207], a[152:155], a[248:251], v[192:207]
    buffer_load_dwordx4 v17, s[36:39], s60 offen offset:3072 lds
    s_lshl_b32 s60, s45, 2
    buffer_load_dword v125, v124, s[4:7], s60 offen offset:128 sc1
    s_waitcnt vmcnt(13)
    ds_read_b64_tr_b16 a[64:65], v23 offset:16384
    ds_read_b64_tr_b16 a[66:67], v23 offset:16896
    v_mfma_f32_32x32x16_bf16 v[208:223], a[152:155], a[252:255], v[208:223]
    ds_read_b64_tr_b16 a[68:69], v24 offset:16384
    ds_read_b64_tr_b16 a[70:71], v24 offset:16896
    v_mfma_f32_32x32x16_bf16 v[224:239], a[148:151], a[240:243], v[224:239]
    ds_read_b64_tr_b16 a[72:73], v23 offset:18432
    ds_read_b64_tr_b16 a[74:75], v23 offset:18944
    ds_read_b64_tr_b16 a[76:77], v24 offset:18432
    ds_read_b64_tr_b16 a[78:79], v24 offset:18944
    v_mfma_f32_32x32x16_bf16 v[240:255], a[148:151], a[244:247], v[240:255]
    s_waitcnt lgkmcnt(8)
    v_mfma_f32_32x32x16_bf16 v[224:239], a[156:159], a[248:251], v[224:239]
    s_waitcnt vmcnt(9)
    ds_read_b64_tr_b16 a[80:81], v23 offset:20480
    ds_read_b64_tr_b16 a[82:83], v23 offset:20992
    v_mfma_f32_32x32x16_bf16 v[240:255], a[156:159], a[252:255], v[240:255]
    ds_read_b64_tr_b16 a[84:85], v24 offset:20480
    ds_read_b64_tr_b16 a[86:87], v24 offset:20992
    v_mfma_f32_32x32x16_bf16 v[128:143], a[160:163], v[32:35], 0
    ds_read_b64_tr_b16 a[88:89], v23 offset:22528
    ds_read_b64_tr_b16 a[90:91], v23 offset:23040
    v_mfma_f32_32x32x16_bf16 v[144:159], a[160:163], v[36:39], 0
    ds_read_b64_tr_b16 a[92:93], v24 offset:22528
    ds_read_b64_tr_b16 a[94:95], v24 offset:23040
    v_mfma_f32_32x32x16_bf16 v[128:143], a[168:171], v[40:43], v[128:143]
    s_waitcnt lgkmcnt(8)
    v_mul_f32 v192, v192, v114
    v_mul_f32 v193, v193, v114
    v_mul_f32 v194, v194, v114
    v_mul_f32 v195, v195, v114
    v_mfma_f32_32x32x16_bf16 v[144:159], a[168:171], v[44:47], v[144:159]
    v_mul_f32 v196, v196, v114
    v_mul_f32 v197, v197, v114
    v_mul_f32 v198, v198, v114
    v_mul_f32 v199, v199, v114
    v_mfma_f32_32x32x16_bf16 v[128:143], a[176:179], v[48:51], v[128:143]
    s_waitcnt vmcnt(5)
    ds_read_b64_tr_b16 a[96:97], v23 offset:0
    ds_read_b64_tr_b16 a[98:99], v23 offset:512
    v_cvt_pk_bf16_f32 v64, v192, v193
    v_cvt_pk_bf16_f32 v65, v194, v195
    v_cvt_pk_bf16_f32 v66, v196, v197
    v_cvt_pk_bf16_f32 v67, v198, v199
    v_mfma_f32_32x32x16_bf16 v[144:159], a[176:179], v[52:55], v[144:159]
    ds_read_b64_tr_b16 a[100:101], v24 offset:0
    ds_read_b64_tr_b16 a[102:103], v24 offset:512
    s_add_u32 s55, s56, 0
    buffer_store_dwordx4 v[64:67], v28, s[40:43], s55 offen sc1
    v_mul_f32 v200, v200, v114
    v_mul_f32 v201, v201, v114
    v_mfma_f32_32x32x16_bf16 v[128:143], a[184:187], v[56:59], v[128:143]
    s_waitcnt lgkmcnt(4)
    ds_read_b64_tr_b16 a[104:105], v23 offset:2048
    ds_read_b64_tr_b16 a[106:107], v23 offset:2560
    v_mul_f32 v202, v202, v114
    v_mul_f32 v203, v203, v114
    v_mul_f32 v204, v204, v114
    v_mul_f32 v205, v205, v114
    v_mfma_f32_32x32x16_bf16 v[144:159], a[184:187], v[60:63], v[144:159]
    ds_read_b64_tr_b16 a[108:109], v24 offset:2048
    ds_read_b64_tr_b16 a[110:111], v24 offset:2560
    v_mul_f32 v206, v206, v114
    v_mul_f32 v207, v207, v114
    v_cvt_pk_bf16_f32 v68, v200, v201
    v_cvt_pk_bf16_f32 v69, v202, v203
    v_mfma_f32_32x32x16_bf16 v[128:143], a[0:3], a[32:35], v[128:143]
    s_waitcnt vmcnt(2)
    ds_read_b64_tr_b16 a[112:113], v23 offset:4096
    ds_read_b64_tr_b16 a[114:115], v23 offset:4608
    v_cvt_pk_bf16_f32 v70, v204, v205
    v_cvt_pk_bf16_f32 v71, v206, v207
    s_add_u32 s55, s56, 16384
    buffer_store_dwordx4 v[68:71], v28, s[40:43], s55 offen sc1
    v_mfma_f32_32x32x16_bf16 v[144:159], a[0:3], a[36:39], v[144:159]
    ds_read_b64_tr_b16 a[116:117], v24 offset:4096
    ds_read_b64_tr_b16 a[118:119], v24 offset:4608
    v_mul_f32 v208, v208, v115
    v_mul_f32 v209, v209, v115
    v_mul_f32 v210, v210, v115
    v_mul_f32 v211, v211, v115
    v_mfma_f32_32x32x16_bf16 v[128:143], a[8:11], a[40:43], v[128:143]
    ds_read_b64_tr_b16 a[120:121], v23 offset:6144
    ds_read_b64_tr_b16 a[122:123], v23 offset:6656
    v_mul_f32 v212, v212, v115
    v_mul_f32 v213, v213, v115
    v_mul_f32 v214, v214, v115
    v_mul_f32 v215, v215, v115
    v_mfma_f32_32x32x16_bf16 v[144:159], a[8:11], a[44:47], v[144:159]
    ds_read_b64_tr_b16 a[124:125], v24 offset:6144
    ds_read_b64_tr_b16 a[126:127], v24 offset:6656
    v_cvt_pk_bf16_f32 v72, v208, v209
    v_cvt_pk_bf16_f32 v73, v210, v211
    v_cvt_pk_bf16_f32 v74, v212, v213
    v_cvt_pk_bf16_f32 v75, v214, v215
    v_mfma_f32_32x32x16_bf16 v[128:143], a[16:19], a[48:51], v[128:143]
    s_waitcnt lgkmcnt(8)
    s_add_u32 s55, s56, 32768
    buffer_store_dwordx4 v[72:75], v28, s[40:43], s55 offen sc1
    v_mul_f32 v216, v216, v115
    v_mul_f32 v217, v217, v115
    v_mfma_f32_32x32x16_bf16 v[144:159], a[16:19], a[52:55], v[144:159]
    v_mul_f32 v218, v218, v115
    v_mul_f32 v219, v219, v115
    v_mul_f32 v220, v220, v115
    v_mul_f32 v221, v221, v115
    v_mfma_f32_32x32x16_bf16 v[128:143], a[24:27], a[56:59], v[128:143]
    v_mul_f32 v222, v222, v115
    v_mul_f32 v223, v223, v115
    v_cvt_pk_bf16_f32 v76, v216, v217
    v_cvt_pk_bf16_f32 v77, v218, v219
    v_mfma_f32_32x32x16_bf16 v[144:159], a[24:27], a[60:63], v[144:159]
    v_cvt_pk_bf16_f32 v78, v220, v221
    v_cvt_pk_bf16_f32 v79, v222, v223
    s_add_u32 s55, s56, 49152
    buffer_store_dwordx4 v[76:79], v28, s[40:43], s55 offen sc1
    v_mfma_f32_32x32x16_bf16 v[128:143], a[64:67], a[192:195], v[128:143]
    s_waitcnt lgkmcnt(0)
    v_mul_f32 v224, v224, v114
    v_mul_f32 v225, v225, v114
    v_mul_f32 v226, v226, v114
    v_mul_f32 v227, v227, v114
    v_mfma_f32_32x32x16_bf16 v[144:159], a[64:67], a[196:199], v[144:159]
    v_mul_f32 v228, v228, v114
    v_mul_f32 v229, v229, v114
    v_mul_f32 v230, v230, v114
    v_mul_f32 v231, v231, v114
    v_mfma_f32_32x32x16_bf16 v[128:143], a[72:75], a[200:203], v[128:143]
    v_cvt_pk_bf16_f32 v80, v224, v225
    v_cvt_pk_bf16_f32 v81, v226, v227
    v_cvt_pk_bf16_f32 v82, v228, v229
    v_cvt_pk_bf16_f32 v83, v230, v231
    v_mfma_f32_32x32x16_bf16 v[144:159], a[72:75], a[204:207], v[144:159]
    s_add_u32 s55, s56, 65536
    buffer_store_dwordx4 v[80:83], v28, s[40:43], s55 offen sc1
    v_mul_f32 v232, v232, v114
    v_mul_f32 v233, v233, v114
    v_mfma_f32_32x32x16_bf16 v[128:143], a[80:83], a[208:211], v[128:143]
    v_mul_f32 v234, v234, v114
    v_mul_f32 v235, v235, v114
    v_mul_f32 v236, v236, v114
    v_mul_f32 v237, v237, v114
    v_mfma_f32_32x32x16_bf16 v[144:159], a[80:83], a[212:215], v[144:159]
    v_mul_f32 v238, v238, v114
    v_mul_f32 v239, v239, v114
    v_cvt_pk_bf16_f32 v84, v232, v233
    v_cvt_pk_bf16_f32 v85, v234, v235
    v_mfma_f32_32x32x16_bf16 v[128:143], a[88:91], a[216:219], v[128:143]
    v_cvt_pk_bf16_f32 v86, v236, v237
    v_cvt_pk_bf16_f32 v87, v238, v239
    s_add_u32 s55, s56, 81920
    buffer_store_dwordx4 v[84:87], v28, s[40:43], s55 offen sc1
    v_mfma_f32_32x32x16_bf16 v[144:159], a[88:91], a[220:223], v[144:159]
    v_mul_f32 v240, v240, v115
    v_mul_f32 v241, v241, v115
    v_mul_f32 v242, v242, v115
    v_mul_f32 v243, v243, v115
    v_mfma_f32_32x32x16_bf16 v[128:143], a[96:99], a[224:227], v[128:143]
    v_mul_f32 v244, v244, v115
    v_mul_f32 v245, v245, v115
    v_mul_f32 v246, v246, v115
    v_mul_f32 v247, v247, v115
    v_mfma_f32_32x32x16_bf16 v[144:159], a[96:99], a[228:231], v[144:159]
    v_cvt_pk_bf16_f32 v88, v240, v241
    v_cvt_pk_bf16_f32 v89, v242, v243
    v_cvt_pk_bf16_f32 v90, v244, v245
    v_cvt_pk_bf16_f32 v91, v246, v247
    v_mfma_f32_32x32x16_bf16 v[128:143], a[104:107], a[232:235], v[128:143]
    s_add_u32 s55, s56, 98304
    buffer_store_dwordx4 v[88:91], v28, s[40:43], s55 offen sc1
    v_mul_f32 v248, v248, v115
    v_mul_f32 v249, v249, v115
    v_mfma_f32_32x32x16_bf16 v[144:159], a[104:107], a[236:239], v[144:159]
    v_mul_f32 v250, v250, v115
    v_mul_f32 v251, v251, v115
    v_mul_f32 v252, v252, v115
    v_mul_f32 v253, v253, v115
    v_mfma_f32_32x32x16_bf16 v[128:143], a[112:115], a[240:243], v[128:143]
    v_mul_f32 v254, v254, v115
    v_mul_f32 v255, v255, v115
    v_cvt_pk_bf16_f32 v92, v248, v249
    v_cvt_pk_bf16_f32 v93, v250, v251
    v_mfma_f32_32x32x16_bf16 v[144:159], a[112:115], a[244:247], v[144:159]
    v_cvt_pk_bf16_f32 v94, v252, v253
    v_cvt_pk_bf16_f32 v95, v254, v255
    s_add_u32 s55, s56, 114688
    buffer_store_dwordx4 v[92:95], v28, s[40:43], s55 offen sc1
    s_lshr_b32 s24, s46, 1
    s_and_b32 s25, s46, 1
    s_lshr_b32 s26, s44, 1
    v_mfma_f32_32x32x16_bf16 v[128:143], a[120:123], a[248:251], v[128:143]
    s_and_b32 s27, s44, 1
    s_lshl_b32 s34, s24, 1
    s_add_u32 s34, s34, s26
    v_mfma_f32_32x32x16_bf16 v[144:159], a[120:123], a[252:255], v[144:159]
    s_lshl_b32 s34, s34, 1
    s_add_u32 s34, s34, s25
    s_lshl_b32 s34, s34, 1
    v_mfma_f32_32x32x16_bf16 v[160:175], a[164:167], v[32:35], 0
    v_mfma_f32_32x32x16_bf16 v[176:191], a[164:167], v[36:39], 0
    v_mfma_f32_32x32x16_bf16 v[160:175], a[172:175], v[40:43], v[160:175]
    s_nop 1
    v_mul_f32 v128, v128, v114
    v_mul_f32 v129, v129, v114
    v_mfma_f32_32x32x16_bf16 v[176:191], a[172:175], v[44:47], v[176:191]
    v_mul_f32 v130, v130, v114
    v_mul_f32 v131, v131, v114
    v_mfma_f32_32x32x16_bf16 v[160:175], a[180:183], v[48:51], v[160:175]
    v_mul_f32 v132, v132, v114
    v_mul_f32 v133, v133, v114
    v_mfma_f32_32x32x16_bf16 v[176:191], a[180:183], v[52:55], v[176:191]
    v_mul_f32 v134, v134, v114
    v_mul_f32 v135, v135, v114
    v_mfma_f32_32x32x16_bf16 v[160:175], a[188:191], v[56:59], v[160:175]
    v_cvt_pk_bf16_f32 v64, v128, v129
    v_cvt_pk_bf16_f32 v65, v130, v131
    v_mfma_f32_32x32x16_bf16 v[176:191], a[188:191], v[60:63], v[176:191]
    v_cvt_pk_bf16_f32 v66, v132, v133
    v_cvt_pk_bf16_f32 v67, v134, v135
    v_mfma_f32_32x32x16_bf16 v[160:175], a[4:7], a[32:35], v[160:175]
    s_add_u32 s55, s57, 0
    buffer_store_dwordx4 v[64:67], v28, s[40:43], s55 offen sc1
    v_mfma_f32_32x32x16_bf16 v[176:191], a[4:7], a[36:39], v[176:191]
    v_mul_f32 v136, v136, v114
    v_mul_f32 v137, v137, v114
    v_mfma_f32_32x32x16_bf16 v[160:175], a[12:15], a[40:43], v[160:175]
    v_mul_f32 v138, v138, v114
    v_mul_f32 v139, v139, v114
    v_mfma_f32_32x32x16_bf16 v[176:191], a[12:15], a[44:47], v[176:191]
    v_mul_f32 v140, v140, v114
    v_mul_f32 v141, v141, v114
    v_mfma_f32_32x32x16_bf16 v[160:175], a[20:23], a[48:51], v[160:175]
    v_mul_f32 v142, v142, v114
    v_mul_f32 v143, v143, v114
    v_mfma_f32_32x32x16_bf16 v[176:191], a[20:23], a[52:55], v[176:191]
    v_cvt_pk_bf16_f32 v68, v136, v137
    v_cvt_pk_bf16_f32 v69, v138, v139
    v_mfma_f32_32x32x16_bf16 v[160:175], a[28:31], a[56:59], v[160:175]
    v_cvt_pk_bf16_f32 v70, v140, v141
    v_cvt_pk_bf16_f32 v71, v142, v143
    v_mfma_f32_32x32x16_bf16 v[176:191], a[28:31], a[60:63], v[176:191]
    s_add_u32 s55, s57, 16384
    buffer_store_dwordx4 v[68:71], v28, s[40:43], s55 offen sc1
    v_mfma_f32_32x32x16_bf16 v[160:175], a[68:71], a[192:195], v[160:175]
    v_mul_f32 v144, v144, v115
    v_mul_f32 v145, v145, v115
    v_mfma_f32_32x32x16_bf16 v[176:191], a[68:71], a[196:199], v[176:191]
    v_mul_f32 v146, v146, v115
    v_mul_f32 v147, v147, v115
    v_mfma_f32_32x32x16_bf16 v[160:175], a[76:79], a[200:203], v[160:175]
    v_mul_f32 v148, v148, v115
    v_mul_f32 v149, v149, v115
    v_mfma_f32_32x32x16_bf16 v[176:191], a[76:79], a[204:207], v[176:191]
    v_mul_f32 v150, v150, v115
    v_mul_f32 v151, v151, v115
    v_mfma_f32_32x32x16_bf16 v[160:175], a[84:87], a[208:211], v[160:175]
    v_cvt_pk_bf16_f32 v72, v144, v145
    v_cvt_pk_bf16_f32 v73, v146, v147
    v_mfma_f32_32x32x16_bf16 v[176:191], a[84:87], a[212:215], v[176:191]
    v_cvt_pk_bf16_f32 v74, v148, v149
    v_cvt_pk_bf16_f32 v75, v150, v151
    v_mfma_f32_32x32x16_bf16 v[160:175], a[92:95], a[216:219], v[160:175]
    s_add_u32 s55, s57, 32768
    buffer_store_dwordx4 v[72:75], v28, s[40:43], s55 offen sc1
    v_mfma_f32_32x32x16_bf16 v[176:191], a[92:95], a[220:223], v[176:191]
    v_mul_f32 v152, v152, v115
    v_mul_f32 v153, v153, v115
    v_mfma_f32_32x32x16_bf16 v[160:175], a[100:103], a[224:227], v[160:175]
    v_mul_f32 v154, v154, v115
    v_mul_f32 v155, v155, v115
    v_mfma_f32_32x32x16_bf16 v[176:191], a[100:103], a[228:231], v[176:191]
    v_mul_f32 v156, v156, v115
    v_mul_f32 v157, v157, v115
    v_mfma_f32_32x32x16_bf16 v[160:175], a[108:111], a[232:235], v[160:175]
    v_mul_f32 v158, v158, v115
    v_mul_f32 v159, v159, v115
    v_mfma_f32_32x32x16_bf16 v[176:191], a[108:111], a[236:239], v[176:191]
    v_cvt_pk_bf16_f32 v76, v152, v153
    v_cvt_pk_bf16_f32 v77, v154, v155
    v_mfma_f32_32x32x16_bf16 v[160:175], a[116:119], a[240:243], v[160:175]
    v_cvt_pk_bf16_f32 v78, v156, v157
    v_cvt_pk_bf16_f32 v79, v158, v159
    v_mfma_f32_32x32x16_bf16 v[176:191], a[116:119], a[244:247], v[176:191]
    s_add_u32 s55, s57, 49152
    buffer_store_dwordx4 v[76:79], v28, s[40:43], s55 offen sc1
    s_add_u32 s34, s34, s27
    s_add_u32 s34, s34, 1
    s_lshl_b32 s34, s34, 14
    v_mfma_f32_32x32x16_bf16 v[160:175], a[124:127], a[248:251], v[160:175]
    s_mul_i32 s28, s45, 966656
    s_add_u32 s34, s34, s28
    s_mul_i32 s35, s25, 28672
    v_mfma_f32_32x32x16_bf16 v[176:191], a[124:127], a[252:255], v[176:191]
    s_add_u32 s35, s35, s12
    s_lshl_b32 s29, s24, 7
    s_add_u32 s35, s35, s29
    s_lshl_b32 s29, s26, 6
    s_add_u32 s35, s35, s29
    s_lshl_b32 s29, s27, 5
    s_add_u32 s35, s35, s29
    v_and_b32 v4, 31, v0
    v_lshrrev_b32 v5, 5, v0
    v_lshlrev_b32 v5, 4, v5
    s_movk_i32 s29, 896
    v_mad_u32_u24 v4, v4, s29, v5
    v_and_b32 v2, 15, v0
    v_lshlrev_b32 v2, 2, v2
    s_add_u32 s28, s28, 933888
    s_lshl_b32 s30, s46, 2
    s_add_u32 s30, s30, s28
    s_lshl_b32 s33, s45, 2
    s_mov_b32 s24, 0x00003f80
    s_mov_b32 s25, 0x3f800000
    s_mov_b32 s32, 0
    v_mul_f32 v160, v160, v114
    v_mul_f32 v161, v161, v114
    v_mul_f32 v162, v162, v114
    v_mul_f32 v163, v163, v114
    v_mul_f32 v164, v164, v114
    v_mul_f32 v165, v165, v114
    v_mul_f32 v166, v166, v114
    v_mul_f32 v167, v167, v114
    v_cvt_pk_bf16_f32 v80, v160, v161
    v_cvt_pk_bf16_f32 v81, v162, v163
    v_cvt_pk_bf16_f32 v82, v164, v165
    v_cvt_pk_bf16_f32 v83, v166, v167
    s_add_u32 s55, s57, 65536
    buffer_store_dwordx4 v[80:83], v28, s[40:43], s55 offen sc1
    v_mul_f32 v168, v168, v114
    v_mul_f32 v169, v169, v114
    v_mul_f32 v170, v170, v114
    v_mul_f32 v171, v171, v114
    v_mul_f32 v172, v172, v114
    v_mul_f32 v173, v173, v114
    v_mul_f32 v174, v174, v114
    v_mul_f32 v175, v175, v114
    v_cvt_pk_bf16_f32 v84, v168, v169
    v_cvt_pk_bf16_f32 v85, v170, v171
    v_cvt_pk_bf16_f32 v86, v172, v173
    v_cvt_pk_bf16_f32 v87, v174, v175
    s_add_u32 s55, s57, 81920
    buffer_store_dwordx4 v[84:87], v28, s[40:43], s55 offen sc1
    v_mul_f32 v176, v176, v115
    v_mul_f32 v177, v177, v115
    v_mul_f32 v178, v178, v115
    v_mul_f32 v179, v179, v115
    v_mul_f32 v180, v180, v115
    v_mul_f32 v181, v181, v115
    v_mul_f32 v182, v182, v115
    v_mul_f32 v183, v183, v115
    v_cvt_pk_bf16_f32 v88, v176, v177
    v_cvt_pk_bf16_f32 v89, v178, v179
    v_cvt_pk_bf16_f32 v90, v180, v181
    v_cvt_pk_bf16_f32 v91, v182, v183
    s_add_u32 s55, s57, 98304
    buffer_store_dwordx4 v[88:91], v28, s[40:43], s55 offen sc1
    v_mul_f32 v184, v184, v115
    v_mul_f32 v185, v185, v115
    v_mul_f32 v186, v186, v115
    v_mul_f32 v187, v187, v115
    v_mul_f32 v188, v188, v115
    v_mul_f32 v189, v189, v115
    v_mul_f32 v190, v190, v115
    v_mul_f32 v191, v191, v115
    v_cvt_pk_bf16_f32 v92, v184, v185
    v_cvt_pk_bf16_f32 v93, v186, v187
    v_cvt_pk_bf16_f32 v94, v188, v189
    v_cvt_pk_bf16_f32 v95, v190, v191
    s_add_u32 s55, s57, 114688
    buffer_store_dwordx4 v[92:95], v28, s[40:43], s55 offen sc1
    s_branch L_fused_reduce

L_fused_reduce:
    s_waitcnt vmcnt(0)
L_fr_tag:
    v_readfirstlane_b32 s31, v125
    s_add_u32 s32, s32, 1
    s_cmp_lg_u32 s31, 0
    s_cbranch_scc1 L_fr_havetag
    s_cmp_ge_u32 s32, 0x200000
    s_cbranch_scc1 L_fr_havetag
    buffer_load_dword v125, v124, s[4:7], s33 offen offset:128 sc1
    s_waitcnt vmcnt(0)
    s_branch L_fr_tag
L_fr_havetag:
    s_barrier
    s_cmp_lg_u32 s44, 3
    s_cbranch_scc1 L_fr_noflag
    s_mov_b64 exec, 1
    buffer_store_dword v125, v124, s[40:43], s30 offen sc1
    s_mov_b64 exec, -1
L_fr_noflag:
    s_cmp_ge_u32 s46, 14
    s_cbranch_scc1 L_end_main
    s_mov_b32 s32, 0
L_fr_poll:
    buffer_load_dword v6, v2, s[40:43], s28 offen sc1
    s_add_u32 s32, s32, 1
    s_waitcnt vmcnt(0)
    v_cmp_ne_u32 vcc, v6, v125
    s_cmp_ge_u32 s32, 0x200000
    s_cbranch_scc1 L_fr_go
    s_nop 2
    s_cbranch_vccnz L_fr_poll
L_fr_go:
    s_add_u32 s29, s34, 0
    buffer_load_dwordx4 v[32:35], v28, s[40:43], s29 offen offset:0 sc1
    buffer_load_dwordx4 v[36:39], v28, s[40:43], s29 offen offset:1024 sc1
    buffer_load_dwordx4 v[40:43], v28, s[40:43], s29 offen offset:2048 sc1
    buffer_load_dwordx4 v[44:47], v28, s[40:43], s29 offen offset:3072 sc1
    s_add_u32 s29, s34, 4096
    buffer_load_dwordx4 v[48:51], v28, s[40:43], s29 offen offset:0 sc1
    buffer_load_dwordx4 v[52:55], v28, s[40:43], s29 offen offset:1024 sc1
    buffer_load_dwordx4 v[56:59], v28, s[40:43], s29 offen offset:2048 sc1
    buffer_load_dwordx4 v[60:63], v28, s[40:43], s29 offen offset:3072 sc1
    s_add_u32 s29, s34, 8192
    buffer_load_dwordx4 v[64:67], v28, s[40:43], s29 offen offset:0 sc1
    buffer_load_dwordx4 v[68:71], v28, s[40:43], s29 offen offset:1024 sc1
    buffer_load_dwordx4 v[72:75], v28, s[40:43], s29 offen offset:2048 sc1
    buffer_load_dwordx4 v[76:79], v28, s[40:43], s29 offen offset:3072 sc1
    s_add_u32 s29, s34, 12288
    buffer_load_dwordx4 v[80:83], v28, s[40:43], s29 offen offset:0 sc1
    buffer_load_dwordx4 v[84:87], v28, s[40:43], s29 offen offset:1024 sc1
    buffer_load_dwordx4 v[88:91], v28, s[40:43], s29 offen offset:2048 sc1
    buffer_load_dwordx4 v[92:95], v28, s[40:43], s29 offen offset:3072 sc1
    s_waitcnt vmcnt(15)
    v_lshlrev_b32 v8, 16, v32
    v_and_b32 v9, 0xffff0000, v32
    v_lshlrev_b32 v10, 16, v33
    v_and_b32 v11, 0xffff0000, v33
    v_lshlrev_b32 v12, 16, v34
    v_and_b32 v13, 0xffff0000, v34
    v_lshlrev_b32 v14, 16, v35
    v_and_b32 v15, 0xffff0000, v35
    s_waitcnt vmcnt(14)
    v_lshlrev_b32 v6, 16, v36
    v_and_b32 v7, 0xffff0000, v36
    v_add_f32 v8, v8, v6
    v_add_f32 v9, v9, v7
    v_lshlrev_b32 v6, 16, v37
    v_and_b32 v7, 0xffff0000, v37
    v_add_f32 v10, v10, v6
    v_add_f32 v11, v11, v7
    v_lshlrev_b32 v6, 16, v38
    v_and_b32 v7, 0xffff0000, v38
    v_add_f32 v12, v12, v6
    v_add_f32 v13, v13, v7
    v_lshlrev_b32 v6, 16, v39
    v_and_b32 v7, 0xffff0000, v39
    v_add_f32 v14, v14, v6
    v_add_f32 v15, v15, v7
    s_waitcnt vmcnt(13)
    v_lshlrev_b32 v6, 16, v40
    v_and_b32 v7, 0xffff0000, v40
    v_add_f32 v8, v8, v6
    v_add_f32 v9, v9, v7
    v_lshlrev_b32 v6, 16, v41
    v_and_b32 v7, 0xffff0000, v41
    v_add_f32 v10, v10, v6
    v_add_f32 v11, v11, v7
    v_lshlrev_b32 v6, 16, v42
    v_and_b32 v7, 0xffff0000, v42
    v_add_f32 v12, v12, v6
    v_add_f32 v13, v13, v7
    v_lshlrev_b32 v6, 16, v43
    v_and_b32 v7, 0xffff0000, v43
    v_add_f32 v14, v14, v6
    v_add_f32 v15, v15, v7
    s_waitcnt vmcnt(12)
    v_lshlrev_b32 v6, 16, v44
    v_and_b32 v7, 0xffff0000, v44
    v_add_f32 v8, v8, v6
    v_add_f32 v9, v9, v7
    v_lshlrev_b32 v6, 16, v45
    v_and_b32 v7, 0xffff0000, v45
    v_add_f32 v10, v10, v6
    v_add_f32 v11, v11, v7
    v_lshlrev_b32 v6, 16, v46
    v_and_b32 v7, 0xffff0000, v46
    v_add_f32 v12, v12, v6
    v_add_f32 v13, v13, v7
    v_lshlrev_b32 v6, 16, v47
    v_and_b32 v7, 0xffff0000, v47
    v_add_f32 v14, v14, v6
    v_add_f32 v15, v15, v7
    s_waitcnt vmcnt(11)
    v_lshlrev_b32 v6, 16, v48
    v_and_b32 v7, 0xffff0000, v48
    v_add_f32 v8, v8, v6
    v_add_f32 v9, v9, v7
    v_lshlrev_b32 v6, 16, v49
    v_and_b32 v7, 0xffff0000, v49
    v_add_f32 v10, v10, v6
    v_add_f32 v11, v11, v7
    v_lshlrev_b32 v6, 16, v50
    v_and_b32 v7, 0xffff0000, v50
    v_add_f32 v12, v12, v6
    v_add_f32 v13, v13, v7
    v_lshlrev_b32 v6, 16, v51
    v_and_b32 v7, 0xffff0000, v51
    v_add_f32 v14, v14, v6
    v_add_f32 v15, v15, v7
    s_waitcnt vmcnt(10)
    v_lshlrev_b32 v6, 16, v52
    v_and_b32 v7, 0xffff0000, v52
    v_add_f32 v8, v8, v6
    v_add_f32 v9, v9, v7
    v_lshlrev_b32 v6, 16, v53
    v_and_b32 v7, 0xffff0000, v53
    v_add_f32 v10, v10, v6
    v_add_f32 v11, v11, v7
    v_lshlrev_b32 v6, 16, v54
    v_and_b32 v7, 0xffff0000, v54
    v_add_f32 v12, v12, v6
    v_add_f32 v13, v13, v7
    v_lshlrev_b32 v6, 16, v55
    v_and_b32 v7, 0xffff0000, v55
    v_add_f32 v14, v14, v6
    v_add_f32 v15, v15, v7
    s_waitcnt vmcnt(9)
    v_lshlrev_b32 v6, 16, v56
    v_and_b32 v7, 0xffff0000, v56
    v_add_f32 v8, v8, v6
    v_add_f32 v9, v9, v7
    v_lshlrev_b32 v6, 16, v57
    v_and_b32 v7, 0xffff0000, v57
    v_add_f32 v10, v10, v6
    v_add_f32 v11, v11, v7
    v_lshlrev_b32 v6, 16, v58
    v_and_b32 v7, 0xffff0000, v58
    v_add_f32 v12, v12, v6
    v_add_f32 v13, v13, v7
    v_lshlrev_b32 v6, 16, v59
    v_and_b32 v7, 0xffff0000, v59
    v_add_f32 v14, v14, v6
    v_add_f32 v15, v15, v7
    s_waitcnt vmcnt(8)
    v_lshlrev_b32 v6, 16, v60
    v_and_b32 v7, 0xffff0000, v60
    v_add_f32 v8, v8, v6
    v_add_f32 v9, v9, v7
    v_lshlrev_b32 v6, 16, v61
    v_and_b32 v7, 0xffff0000, v61
    v_add_f32 v10, v10, v6
    v_add_f32 v11, v11, v7
    v_lshlrev_b32 v6, 16, v62
    v_and_b32 v7, 0xffff0000, v62
    v_add_f32 v12, v12, v6
    v_add_f32 v13, v13, v7
    v_lshlrev_b32 v6, 16, v63
    v_and_b32 v7, 0xffff0000, v63
    v_add_f32 v14, v14, v6
    v_add_f32 v15, v15, v7
    s_waitcnt vmcnt(7)
    v_lshlrev_b32 v6, 16, v64
    v_and_b32 v7, 0xffff0000, v64
    v_add_f32 v8, v8, v6
    v_add_f32 v9, v9, v7
    v_lshlrev_b32 v6, 16, v65
    v_and_b32 v7, 0xffff0000, v65
    v_add_f32 v10, v10, v6
    v_add_f32 v11, v11, v7
    v_lshlrev_b32 v6, 16, v66
    v_and_b32 v7, 0xffff0000, v66
    v_add_f32 v12, v12, v6
    v_add_f32 v13, v13, v7
    v_lshlrev_b32 v6, 16, v67
    v_and_b32 v7, 0xffff0000, v67
    v_add_f32 v14, v14, v6
    v_add_f32 v15, v15, v7
    s_waitcnt vmcnt(6)
    v_lshlrev_b32 v6, 16, v68
    v_and_b32 v7, 0xffff0000, v68
    v_add_f32 v8, v8, v6
    v_add_f32 v9, v9, v7
    v_lshlrev_b32 v6, 16, v69
    v_and_b32 v7, 0xffff0000, v69
    v_add_f32 v10, v10, v6
    v_add_f32 v11, v11, v7
    v_lshlrev_b32 v6, 16, v70
    v_and_b32 v7, 0xffff0000, v70
    v_add_f32 v12, v12, v6
    v_add_f32 v13, v13, v7
    v_lshlrev_b32 v6, 16, v71
    v_and_b32 v7, 0xffff0000, v71
    v_add_f32 v14, v14, v6
    v_add_f32 v15, v15, v7
    s_waitcnt vmcnt(5)
    v_lshlrev_b32 v6, 16, v72
    v_and_b32 v7, 0xffff0000, v72
    v_add_f32 v8, v8, v6
    v_add_f32 v9, v9, v7
    v_lshlrev_b32 v6, 16, v73
    v_and_b32 v7, 0xffff0000, v73
    v_add_f32 v10, v10, v6
    v_add_f32 v11, v11, v7
    v_lshlrev_b32 v6, 16, v74
    v_and_b32 v7, 0xffff0000, v74
    v_add_f32 v12, v12, v6
    v_add_f32 v13, v13, v7
    v_lshlrev_b32 v6, 16, v75
    v_and_b32 v7, 0xffff0000, v75
    v_add_f32 v14, v14, v6
    v_add_f32 v15, v15, v7
    s_waitcnt vmcnt(4)
    v_lshlrev_b32 v6, 16, v76
    v_and_b32 v7, 0xffff0000, v76
    v_add_f32 v8, v8, v6
    v_add_f32 v9, v9, v7
    v_lshlrev_b32 v6, 16, v77
    v_and_b32 v7, 0xffff0000, v77
    v_add_f32 v10, v10, v6
    v_add_f32 v11, v11, v7
    v_lshlrev_b32 v6, 16, v78
    v_and_b32 v7, 0xffff0000, v78
    v_add_f32 v12, v12, v6
    v_add_f32 v13, v13, v7
    v_lshlrev_b32 v6, 16, v79
    v_and_b32 v7, 0xffff0000, v79
    v_add_f32 v14, v14, v6
    v_add_f32 v15, v15, v7
    s_waitcnt vmcnt(3)
    v_lshlrev_b32 v6, 16, v80
    v_and_b32 v7, 0xffff0000, v80
    v_add_f32 v8, v8, v6
    v_add_f32 v9, v9, v7
    v_lshlrev_b32 v6, 16, v81
    v_and_b32 v7, 0xffff0000, v81
    v_add_f32 v10, v10, v6
    v_add_f32 v11, v11, v7
    v_lshlrev_b32 v6, 16, v82
    v_and_b32 v7, 0xffff0000, v82
    v_add_f32 v12, v12, v6
    v_add_f32 v13, v13, v7
    v_lshlrev_b32 v6, 16, v83
    v_and_b32 v7, 0xffff0000, v83
    v_add_f32 v14, v14, v6
    v_add_f32 v15, v15, v7
    s_waitcnt vmcnt(2)
    v_lshlrev_b32 v6, 16, v84
    v_and_b32 v7, 0xffff0000, v84
    v_add_f32 v8, v8, v6
    v_add_f32 v9, v9, v7
    v_lshlrev_b32 v6, 16, v85
    v_and_b32 v7, 0xffff0000, v85
    v_add_f32 v10, v10, v6
    v_add_f32 v11, v11, v7
    v_lshlrev_b32 v6, 16, v86
    v_and_b32 v7, 0xffff0000, v86
    v_add_f32 v12, v12, v6
    v_add_f32 v13, v13, v7
    v_lshlrev_b32 v6, 16, v87
    v_and_b32 v7, 0xffff0000, v87
    v_add_f32 v14, v14, v6
    v_add_f32 v15, v15, v7
    s_waitcnt vmcnt(1)
    v_lshlrev_b32 v6, 16, v88
    v_and_b32 v7, 0xffff0000, v88
    v_add_f32 v8, v8, v6
    v_add_f32 v9, v9, v7
    v_lshlrev_b32 v6, 16, v89
    v_and_b32 v7, 0xffff0000, v89
    v_add_f32 v10, v10, v6
    v_add_f32 v11, v11, v7
    v_lshlrev_b32 v6, 16, v90
    v_and_b32 v7, 0xffff0000, v90
    v_add_f32 v12, v12, v6
    v_add_f32 v13, v13, v7
    v_lshlrev_b32 v6, 16, v91
    v_and_b32 v7, 0xffff0000, v91
    v_add_f32 v14, v14, v6
    v_add_f32 v15, v15, v7
    s_waitcnt vmcnt(0)
    v_lshlrev_b32 v6, 16, v92
    v_and_b32 v7, 0xffff0000, v92
    v_add_f32 v8, v8, v6
    v_add_f32 v9, v9, v7
    v_lshlrev_b32 v6, 16, v93
    v_and_b32 v7, 0xffff0000, v93
    v_add_f32 v10, v10, v6
    v_add_f32 v11, v11, v7
    v_lshlrev_b32 v6, 16, v94
    v_and_b32 v7, 0xffff0000, v94
    v_add_f32 v12, v12, v6
    v_add_f32 v13, v13, v7
    v_lshlrev_b32 v6, 16, v95
    v_and_b32 v7, 0xffff0000, v95
    v_add_f32 v14, v14, v6
    v_add_f32 v15, v15, v7
    s_nop 2
    v_cvt_pk_bf16_f32 v16, v8, v9
    v_cvt_pk_bf16_f32 v17, v10, v11
    v_cvt_pk_bf16_f32 v18, v12, v13
    v_cvt_pk_bf16_f32 v19, v14, v15
    buffer_store_dwordx4 v[16:19], v4, s[8:11], s35 offen
    s_endpgm
L_code_end:
L_end_main:
    s_endpgm
.section .rodata,"a"
.p2align 6
.amdhsa_kernel standalone__gqa_block_cached__near_ridge_kernel
  .amdhsa_next_free_vgpr 512
  .amdhsa_next_free_sgpr 102
  .amdhsa_accum_offset 256
  .amdhsa_group_segment_fixed_size 0
  .amdhsa_kernarg_size 64
  .amdhsa_user_sgpr_count 2
  .amdhsa_user_sgpr_kernarg_segment_ptr 1
  .amdhsa_system_sgpr_workgroup_id_x 1
.end_amdhsa_kernel
```
